```python
import torch

def _softmax(x, axis=-1):
    return torch.softmax(x, dim=axis)

def _gelu(x):
    return torch.nn.functional.gelu(x, approximate='tanh')

def _silu(x):
    return torch.nn.functional.silu(x)

def _sigmoid(x):
    return torch.sigmoid(x)

def _layernorm(x, axis=-1, eps=1e-05):
    m = x.mean(dim=axis, keepdim=True)
    v = x.var(dim=axis, keepdim=True, unbiased=False)
    return (x - m) / torch.sqrt(v + eps)

def _scatter_add(tgt, idx, src, axis=0):
    return tgt.clone().index_add_(axis, idx, src)

def _segment_sum(src, seg, n):
    out = torch.zeros((n,) + src.shape[1:], dtype=src.dtype)
    return out.index_add_(0, seg, src)

def _pad(x, pw):
    flat = tuple((v for pair in reversed(pw) for v in pair))
    return torch.nn.functional.pad(x, flat)
kernel_name = 'parallel_sum__mha_block__mixer_gmlp__prompt'

def setup_inputs():

    _w = lambda a: (lambda t: t.to(torch.bfloat16) if t.is_floating_point() else t)(torch.as_tensor(a))

    def _A_setup():
        B, S, D, H = (1, 2048, 512, 32)
        return {'x': _w((lambda *s: torch.randn(*s, dtype=torch.bfloat16) * 0.05)(B, S, D)), 'wqkv': _w((lambda *s: torch.randn(*s, dtype=torch.bfloat16) * 0.2)(D, 3 * D)), 'wo': _w((lambda *s: torch.randn(*s, dtype=torch.bfloat16) * 0.2)(D, D))}
    _A_in = _A_setup()

    def _B_setup():
        B, S, D, F = (1, 2048, 512, 1792)
        Fh = F // 2
        return {'x': _w((lambda *s: torch.randn(*s, dtype=torch.bfloat16) * 0.05)(B, S, D)), 'w_in': _w((lambda *s: torch.randn(*s, dtype=torch.bfloat16) * 0.8)(D, 2 * Fh)), 'w_sp': _w(0.01 * (lambda *s: torch.randn(*s, dtype=torch.bfloat16) * 0.8)(S, S)), 'b_sp': _w(1.0 + 0.01 * (lambda *s: torch.randn(*s, dtype=torch.bfloat16) * 0.2)(S)), 'w_out': _w((lambda *s: torch.randn(*s, dtype=torch.bfloat16) * 0.2)(Fh, D))}
    _B_in = _B_setup()
    return {'A_x': _A_in['x'], 'A_wqkv': _A_in['wqkv'], 'A_wo': _A_in['wo'], 'B_x': _B_in['x'], 'B_w_in': _B_in['w_in'], 'B_w_sp': _B_in['w_sp'], 'B_b_sp': _B_in['b_sp'], 'B_w_out': _B_in['w_out']}

def reference(A_x, A_wqkv, A_wo, B_x, B_w_in, B_w_sp, B_b_sp, B_w_out):

    def _A_ref(x, wqkv, wo):
        B, S, D = x.shape
        H = 32
        Dh = D // H
        qkv = (lambda x, *d: x.permute(*d))((x @ wqkv).reshape(B, S, 3, H, Dh), 2, 0, 3, 1, 4)
        q, k, v = (qkv[0], qkv[1], qkv[2])
        scores = torch.einsum('bhqd,bhkd->bhqk', q, k) * Dh ** (-0.5)
        p = _softmax(scores, axis=-1)
        o = torch.einsum('bhqk,bhkd->bhqd', p, v)
        return (lambda x, *d: x.permute(*d))(o, 0, 2, 1, 3).reshape(B, S, D) @ wo

    def _B_ref(x, w_in, w_sp, b_sp, w_out):
        B, S, D = x.shape
        F = w_in.shape[-1]
        Fh = F // 2
        z = _gelu(torch.einsum('bsd,df->bsf', x, w_in))
        z1 = z[..., :Fh].clone()
        z2 = _layernorm(z[..., Fh:], axis=-1)
        g = torch.einsum('ts,bsf->btf', w_sp, z2) + b_sp[None, :, None]
        return torch.einsum('bsf,fd->bsd', z1 * g, w_out)
    x = A_x
    xn = _layernorm(x, axis=-1)
    return x + _A_ref(xn, A_wqkv, A_wo) + _B_ref(xn, B_w_in, B_w_sp, B_b_sp, B_w_out)
```

```asm
; @launch grid=(256,1,1) block=(512,1,1) lds=163840
.amdgcn_target "amdgcn-amd-amdhsa--gfx950"
.text
.globl parallel_sum__mha_block__mixer_gmlp__prompt_kernel
.p2align 8
.type parallel_sum__mha_block__mixer_gmlp__prompt_kernel,@function
parallel_sum__mha_block__mixer_gmlp__prompt_kernel:
    s_cmp_ge_u32 s2, 256
    s_cbranch_scc1 L_pa_end
    s_load_dwordx4 s[4:7], s[0:1], 0
    s_load_dwordx2 s[8:9], s[0:1], 32
    s_load_dwordx4 s[48:51], s[0:1], 72
    v_and_b32 v1, 63, v0
    v_lshrrev_b32 v2, 6, v0
    s_nop 0
    v_readfirstlane_b32 s28, v2
    s_nop 0
    s_mov_b32 s10, s28
    s_and_b32 s29, s2, 7
    s_lshr_b32 s30, s2, 3
    s_and_b32 s31, s29, 1
    s_lshl_b32 s31, s31, 3
    s_and_b32 s32, s30, 7
    s_add_u32 s31, s31, s32
    s_lshr_b32 s32, s29, 1
    s_lshl_b32 s32, s32, 2
    s_lshr_b32 s33, s30, 3
    s_add_u32 s32, s32, s33
    v_lshrrev_b32 v2, 3, v1
    v_lshrrev_b32 v3, 4, v1
    v_xor_b32 v116, v3, v1
    v_and_b32 v116, 7, v116
    v_lshlrev_b32 v116, 4, v116
    v_lshl_add_u32 v116, v2, 10, v116
    v_and_b32 v3, 1, v3
    v_lshlrev_b32 v3, 2, v3
    v_xor_b32 v3, v3, v1
    v_and_b32 v3, 7, v3
    v_lshlrev_b32 v123, 4, v3
    v_mul_u32_u24 v121, 3584, v2
    v_add_u32 v121, v121, v123
    v_mul_u32_u24 v0, 3072, v2
    v_add_u32 v0, v0, v123
    v_lshrrev_b32 v2, 2, v1
    v_and_b32 v3, 3, v1
    v_lshlrev_b32 v3, 4, v3
    v_mul_u32_u24 v122, 3072, v2
    v_add_u32 v122, v122, v3
    s_and_b32 s29, s28, 3
    s_lshr_b32 s30, s28, 2
    s_lshl_b32 s33, s31, 2
    s_add_u32 s33, s33, s29
    s_lshl_b32 s56, s33, 15
    s_lshl_b32 s34, s30, 7
    s_add_u32 s56, s56, s34
    s_lshl_b32 s57, s29, 14
    s_lshl_b32 s34, s30, 12
    s_add_u32 s59, s57, s34
    s_mul_i32 s58, s28, 3072
    s_lshl_b32 s55, s28, 11
    v_xor_b32 v117, 64, v116
    v_add_u32 v118, 16384, v116
    v_add_u32 v117, 8192, v117
    v_add_u32 v119, 16384, v117
    s_mul_i32 s80, s28, 57344
    s_lshl_b32 s35, s32, 7
    s_add_u32 s80, s80, s35
    s_mul_i32 s81, s28, 49152
    s_lshl_b32 s35, s32, 6
    s_and_b32 s34, s32, 1
    s_mul_i32 s34, s34, 960
    s_add_u32 s82, s81, s34
    s_add_u32 s81, s81, s35
    s_add_u32 s82, s82, s35
    s_mov_b32 s35, s31
    s_add_u32 s34, s35, 0
    s_and_b32 s34, s34, 3
    s_lshl_b32 s60, s34, 8
    s_mul_i32 s64, s34, 458752
    s_mul_i32 s96, s34, 393216
    s_add_u32 s34, s35, 1
    s_and_b32 s34, s34, 3
    s_lshl_b32 s61, s34, 8
    s_mul_i32 s65, s34, 458752
    s_mul_i32 s97, s34, 393216
    s_add_u32 s34, s35, 2
    s_and_b32 s34, s34, 3
    s_lshl_b32 s62, s34, 8
    s_mul_i32 s66, s34, 458752
    s_mul_i32 s98, s34, 393216
    s_add_u32 s34, s35, 3
    s_and_b32 s34, s34, 3
    s_lshl_b32 s63, s34, 8
    s_mul_i32 s67, s34, 458752
    s_mul_i32 s99, s34, 393216
    s_cmp_lt_u32 s32, 14
    s_cselect_b32 s18, 1835008, 0
    s_cselect_b32 s42, 33554432, 0
    s_mov_b32 s19, 0x20000
    s_mov_b32 s43, 0x20000
    s_waitcnt lgkmcnt(0)
    s_mov_b32 s16, s8
    s_mov_b32 s17, s9
    s_lshr_b32 s9, s29, 1
    s_lshl_b32 s9, s9, 14
    s_and_b32 s8, s29, 1
    s_lshl_b32 s8, s8, 12
    s_add_u32 s9, s9, s8
    s_mov_b32 s24, s4
    s_mov_b32 s25, s5
    s_mov_b32 s26, 0x200000
    s_mov_b32 s27, 0x20000
    s_mov_b32 s20, s6
    s_mov_b32 s21, s7
    s_mov_b32 s22, 0x180000
    s_mov_b32 s23, 0x20000
    s_add_u32 m0, s59, 0
    s_add_u32 s69, s56, s60
    buffer_load_dwordx4 v116, s[24:27], s69 offen lds
    s_add_u32 m0, s59, 1024
    s_add_u32 s69, s56, s60
    buffer_load_dwordx4 v117, s[24:27], s69 offen lds
    s_add_u32 m0, s59, 2048
    s_add_u32 s69, s56, s60
    buffer_load_dwordx4 v118, s[24:27], s69 offen lds
    s_add_u32 m0, s59, 3072
    s_add_u32 s69, s56, s60
    buffer_load_dwordx4 v119, s[24:27], s69 offen lds
    s_add_u32 m0, s58, 65536
    s_add_u32 s69, s80, s64
    s_add_u32 s69, s69, 1792
    buffer_load_dwordx4 v121, s[16:19], s69 offen lds
    s_add_u32 m0, s58, 66560
    s_add_u32 s69, s80, s64
    s_add_u32 s69, s69, 30464
    buffer_load_dwordx4 v121, s[16:19], s69 offen lds
    s_add_u32 m0, s58, 67584
    s_add_u32 s69, s81, s96
    s_add_u32 s69, s69, 2048
    buffer_load_dwordx4 v122, s[20:23], s69 offen lds
    s_mov_b32 s12, s50
    s_mov_b32 s13, s51
    s_mov_b32 s14, 0x2000000
    s_mov_b32 s15, 0x20000
    s_mov_b32 s44, s48
    s_mov_b32 s45, s49
    s_mov_b32 s46, 0x100
    s_mov_b32 s47, 0x20000
    s_mov_b32 s40, s50
    s_mov_b32 s41, s51
    v_and_b32 v123, 31, v1
    v_lshrrev_b32 v3, 1, v123
    v_xor_b32 v3, v3, v123
    v_and_b32 v3, 4, v3
    v_mul_u32_u24 v3, 3, v3
    v_xor_b32 v123, v123, v3
    v_lshrrev_b32 v3, 1, v123
    v_lshrrev_b32 v2, 5, v1
    v_xor_b32 v3, v3, v2
    v_and_b32 v3, 7, v3
    v_lshlrev_b32 v3, 4, v3
    v_lshl_add_u32 v112, v123, 7, v3
    v_add_u32 v112, s57, v112
    v_xor_b32 v113, 32, v112
    v_xor_b32 v114, 64, v112
    v_xor_b32 v115, 96, v112
    s_add_u32 m0, s59, 8192
    s_add_u32 s69, s56, s61
    buffer_load_dwordx4 v116, s[24:27], s69 offen lds
    s_add_u32 m0, s59, 9216
    s_add_u32 s69, s56, s61
    buffer_load_dwordx4 v117, s[24:27], s69 offen lds
    s_add_u32 m0, s59, 10240
    s_add_u32 s69, s56, s61
    buffer_load_dwordx4 v118, s[24:27], s69 offen lds
    s_add_u32 m0, s59, 11264
    s_add_u32 s69, s56, s61
    buffer_load_dwordx4 v119, s[24:27], s69 offen lds
    s_add_u32 m0, s58, 90112
    s_add_u32 s69, s80, s65
    s_add_u32 s69, s69, 1792
    buffer_load_dwordx4 v121, s[16:19], s69 offen lds
    s_add_u32 m0, s58, 91136
    s_add_u32 s69, s80, s65
    s_add_u32 s69, s69, 30464
    buffer_load_dwordx4 v121, s[16:19], s69 offen lds
    s_add_u32 m0, s58, 92160
    s_add_u32 s69, s81, s97
    s_add_u32 s69, s69, 2048
    buffer_load_dwordx4 v122, s[20:23], s69 offen lds
    s_getpc_b64 s[36:37]
L_pa_cpf:
    s_lshl_b32 s38, s28, 13
    v_lshl_add_u32 v3, v1, 7, s38
    v_min_u32 v3, CODE_END-L_pa_cpf-4, v3
    global_load_dword v36, v3, s[36:37]
    s_or_b32 s34, s2, s28
    s_cmp_lg_u32 s34, 0
    s_cbranch_scc1 L_pa_notag
    s_mov_b32 s34, 28325888
    buffer_load_dword v2, off, s[12:15], s34 sc1
    s_waitcnt vmcnt(0)
    v_add_u32 v2, 1, v2
    v_max_u32 v2, 1, v2
    buffer_store_dword v2, off, s[44:47], 0 sc1
    buffer_store_dword v2, off, s[12:15], s34 sc1
L_pa_notag:
    v_lshlrev_b32 v120, 4, v1
    v_and_b32 v3, 3, v1
    v_cmp_eq_u32 vcc, 0, v3
    v_lshrrev_b32 v3, 2, v1
    v_lshrrev_b32 v2, 4, v1
    v_xor_b32 v3, v3, v2
    v_and_b32 v3, 1, v3
    v_cmp_eq_u32 s[34:35], 0, v3
    s_nop 0
    s_and_b64 vcc, vcc, s[34:35]
    v_mov_b32 v3, 0x3f803f80
    v_cndmask_b32 v108, 0, v3, vcc
    v_mov_b32 v109, v108
    v_mov_b32 v110, v108
    v_mov_b32 v111, v108
    v_cmp_lt_u32 s[74:75], 31, v1
    s_mov_b32 s76, 0x3b000000
    s_cmp_eq_u32 s30, 0
    s_cbranch_scc1 L_pa_g1
    v_lshrrev_b32 v2, 5, v1
    v_lshlrev_b32 v124, 10, v2
    v_bfe_u32 v3, v1, 2, 2
    v_lshl_add_u32 v124, v3, 7, v124
    v_bfe_u32 v3, v1, 4, 1
    v_lshl_add_u32 v124, v3, 5, v124
    v_and_b32 v3, 1, v1
    v_lshl_add_u32 v124, v3, 4, v124
    v_bfe_u32 v3, v1, 1, 1
    v_lshl_add_u32 v124, v3, 3, v124
    v_bfe_u32 v3, v1, 3, 1
    v_lshl_add_u32 v124, v3, 6, v124
    v_add_u32 v124, 65536, v124
    s_mul_i32 s34, s29, 3072
    v_xor_b32 v125, 64, v124
    v_add_u32 v126, s34, v124
    v_add_u32 v127, s34, v125
    s_mov_b32 s77, 0xbdd2d3e8
    s_lshr_b32 s34, s32, 1
    s_lshl_b32 s83, s34, 19
    s_lshl_b32 s35, s33, 13
    s_add_u32 s83, s83, s35
    s_and_b32 s35, s32, 1
    s_lshl_b32 s35, s35, 11
    s_add_u32 s83, s83, s35
    s_add_u32 s83, s83, 10485760
    s_add_u32 s84, s83, 4096
    s_lshl_b32 s87, s33, 13
    s_add_u32 s87, s87, 27262976
    s_lshl_b32 s35, s32, 9
    s_add_u32 s88, s87, s35
    s_mul_i32 s85, s33, 57344
    s_lshl_b32 s34, s32, 12
    s_add_u32 s85, s85, s34
    s_add_u32 s85, s85, 6815744
    s_lshl_b32 s86, s32, 11
    s_lshl_b32 s34, s31, 7
    s_add_u32 s86, s86, s34
    s_lshl_b32 s34, s29, 2
    s_add_u32 s86, s86, s34
    s_add_u32 s86, s86, 28344336
    s_lshl_b32 s52, s29, 11
    s_add_u32 s52, s52, 65536
    s_setprio 1
    s_waitcnt vmcnt(7)
    s_barrier
    ds_read_b128 v[128:131], v112 offset:0
    ds_read_b128 v[132:135], v113 offset:0
    ds_read_b128 v[136:139], v114 offset:0
    ds_read_b128 v[140:143], v115 offset:0
    ds_read_b64_tr_b16 v[68:69], v124 offset:0
    ds_read_b64_tr_b16 v[70:71], v124 offset:512
    ds_read_b64_tr_b16 v[72:73], v125 offset:0
    ds_read_b64_tr_b16 v[74:75], v125 offset:512
    ds_read_b64_tr_b16 v[76:77], v124 offset:3072
    ds_read_b64_tr_b16 v[78:79], v124 offset:3584
    ds_read_b64_tr_b16 v[80:81], v125 offset:3072
    ds_read_b64_tr_b16 v[82:83], v125 offset:3584
    s_waitcnt lgkmcnt(4)
    v_mfma_f32_32x32x16_bf16 v[4:19], v[128:131], v[68:71], 0
    ds_read_b64_tr_b16 v[92:93], v126 offset:0
    ds_read_b64_tr_b16 v[94:95], v126 offset:512
    ds_read_b64_tr_b16 v[96:97], v127 offset:0
    ds_read_b64_tr_b16 v[98:99], v127 offset:512
    ds_read_b64_tr_b16 v[84:85], v124 offset:6144
    ds_read_b64_tr_b16 v[86:87], v124 offset:6656
    ds_read_b64_tr_b16 v[88:89], v125 offset:6144
    ds_read_b64_tr_b16 v[90:91], v125 offset:6656
    ds_read_b128 v[144:147], v112 offset:4096
    v_mfma_f32_32x32x16_bf16 v[20:35], v[128:131], v[72:75], 0
    s_add_u32 m0, s58, 114688
    s_add_u32 s69, s80, s66
    s_add_u32 s69, s69, 1792
    buffer_load_dwordx4 v121, s[16:19], s69 offen lds
    s_waitcnt lgkmcnt(5)
    v_mfma_f32_32x32x16_bf16 v[4:19], v[132:135], v[76:79], v[4:19]
    ds_read_b64_tr_b16 v[68:69], v124 offset:9216
    ds_read_b64_tr_b16 v[70:71], v124 offset:9728
    ds_read_b64_tr_b16 v[72:73], v125 offset:9216
    ds_read_b64_tr_b16 v[74:75], v125 offset:9728
    ds_read_b128 v[148:151], v113 offset:4096
    v_mfma_f32_32x32x16_bf16 v[20:35], v[132:135], v[80:83], v[20:35]
    v_mfma_f32_16x16x32_bf16 v[100:103], v[108:111], v[92:95], 0
    v_mfma_f32_16x16x32_bf16 v[104:107], v[108:111], v[96:99], 0
    s_add_u32 m0, s58, 115712
    s_add_u32 s69, s80, s66
    s_add_u32 s69, s69, 30464
    buffer_load_dwordx4 v121, s[16:19], s69 offen lds
    s_waitcnt lgkmcnt(6)
    v_mfma_f32_32x32x16_bf16 v[4:19], v[136:139], v[84:87], v[4:19]
    ds_read_b64_tr_b16 v[76:77], v124 offset:12288
    ds_read_b64_tr_b16 v[78:79], v124 offset:12800
    ds_read_b64_tr_b16 v[80:81], v125 offset:12288
    ds_read_b64_tr_b16 v[82:83], v125 offset:12800
    ds_read_b128 v[152:155], v114 offset:4096
    v_mfma_f32_32x32x16_bf16 v[20:35], v[136:139], v[88:91], v[20:35]
    s_add_u32 m0, s58, 116736
    s_add_u32 s69, s81, s98
    s_add_u32 s69, s69, 2048
    buffer_load_dwordx4 v122, s[20:23], s69 offen lds
    s_waitcnt lgkmcnt(6)
    v_mfma_f32_32x32x16_bf16 v[4:19], v[140:143], v[68:71], v[4:19]
    ds_read_b64_tr_b16 v[84:85], v124 offset:15360
    ds_read_b64_tr_b16 v[86:87], v124 offset:15872
    ds_read_b64_tr_b16 v[88:89], v125 offset:15360
    ds_read_b64_tr_b16 v[90:91], v125 offset:15872
    ds_read_b128 v[156:159], v115 offset:4096
    v_mfma_f32_32x32x16_bf16 v[20:35], v[140:143], v[72:75], v[20:35]
    s_add_u32 m0, s58, 139264
    s_add_u32 s69, s80, s67
    s_add_u32 s69, s69, 1792
    buffer_load_dwordx4 v121, s[16:19], s69 offen lds
    s_waitcnt lgkmcnt(6)
    v_mfma_f32_32x32x16_bf16 v[4:19], v[144:147], v[76:79], v[4:19]
    ds_read_b64_tr_b16 v[92:93], v126 offset:12288
    ds_read_b64_tr_b16 v[94:95], v126 offset:12800
    ds_read_b64_tr_b16 v[96:97], v127 offset:12288
    ds_read_b64_tr_b16 v[98:99], v127 offset:12800
    ds_read_b64_tr_b16 v[68:69], v124 offset:18432
    ds_read_b64_tr_b16 v[70:71], v124 offset:18944
    ds_read_b64_tr_b16 v[72:73], v125 offset:18432
    ds_read_b64_tr_b16 v[74:75], v125 offset:18944
    v_mfma_f32_32x32x16_bf16 v[20:35], v[144:147], v[80:83], v[20:35]
    s_add_u32 m0, s58, 140288
    s_add_u32 s69, s80, s67
    s_add_u32 s69, s69, 30464
    buffer_load_dwordx4 v121, s[16:19], s69 offen lds
    s_waitcnt lgkmcnt(4)
    v_mfma_f32_32x32x16_bf16 v[4:19], v[148:151], v[84:87], v[4:19]
    ds_read_b64_tr_b16 v[76:77], v124 offset:21504
    ds_read_b64_tr_b16 v[78:79], v124 offset:22016
    ds_read_b64_tr_b16 v[80:81], v125 offset:21504
    ds_read_b64_tr_b16 v[82:83], v125 offset:22016
    v_mfma_f32_32x32x16_bf16 v[20:35], v[148:151], v[88:91], v[20:35]
    v_mfma_f32_16x16x32_bf16 v[100:103], v[108:111], v[92:95], v[100:103]
    v_mfma_f32_16x16x32_bf16 v[104:107], v[108:111], v[96:99], v[104:107]
    s_add_u32 m0, s58, 141312
    s_add_u32 s69, s81, s99
    s_add_u32 s69, s69, 2048
    buffer_load_dwordx4 v122, s[20:23], s69 offen lds
    s_waitcnt lgkmcnt(4)
    v_mfma_f32_32x32x16_bf16 v[4:19], v[152:155], v[68:71], v[4:19]
    s_waitcnt vmcnt(6) lgkmcnt(0)
    s_barrier
    ds_read_b64_tr_b16 v[84:85], v124 offset:24576
    ds_read_b64_tr_b16 v[86:87], v124 offset:25088
    ds_read_b64_tr_b16 v[88:89], v125 offset:24576
    ds_read_b64_tr_b16 v[90:91], v125 offset:25088
    ds_read_b128 v[160:163], v112 offset:8192
    ds_read_b128 v[164:167], v113 offset:8192
    v_mfma_f32_32x32x16_bf16 v[20:35], v[152:155], v[72:75], v[20:35]
    s_add_u32 m0, s59, 0
    s_add_u32 s69, s56, s62
    buffer_load_dwordx4 v116, s[24:27], s69 offen lds
    v_mfma_f32_32x32x16_bf16 v[4:19], v[156:159], v[76:79], v[4:19]
    ds_read_b64_tr_b16 v[68:69], v124 offset:27648
    ds_read_b64_tr_b16 v[70:71], v124 offset:28160
    ds_read_b64_tr_b16 v[72:73], v125 offset:27648
    ds_read_b64_tr_b16 v[74:75], v125 offset:28160
    ds_read_b128 v[168:171], v114 offset:8192
    ds_read_b128 v[172:175], v115 offset:8192
    v_mfma_f32_32x32x16_bf16 v[20:35], v[156:159], v[80:83], v[20:35]
    s_add_u32 m0, s59, 1024
    s_add_u32 s69, s56, s62
    buffer_load_dwordx4 v117, s[24:27], s69 offen lds
    s_waitcnt lgkmcnt(7)
    v_mfma_f32_32x32x16_bf16 v[4:19], v[160:163], v[84:87], v[4:19]
    ds_read_b64_tr_b16 v[92:93], v126 offset:24576
    ds_read_b64_tr_b16 v[94:95], v126 offset:25088
    ds_read_b64_tr_b16 v[96:97], v127 offset:24576
    ds_read_b64_tr_b16 v[98:99], v127 offset:25088
    ds_read_b64_tr_b16 v[76:77], v124 offset:30720
    ds_read_b64_tr_b16 v[78:79], v124 offset:31232
    ds_read_b64_tr_b16 v[80:81], v125 offset:30720
    s_waitcnt lgkmcnt(12)
    ds_read_b64_tr_b16 v[82:83], v125 offset:31232
    ds_read_b128 v[176:179], v112 offset:12288
    v_mfma_f32_32x32x16_bf16 v[20:35], v[160:163], v[88:91], v[20:35]
    s_add_u32 m0, s59, 2048
    s_add_u32 s69, s56, s62
    buffer_load_dwordx4 v118, s[24:27], s69 offen lds
    s_waitcnt lgkmcnt(5)
    v_mfma_f32_32x32x16_bf16 v[4:19], v[164:167], v[68:71], v[4:19]
    ds_read_b64_tr_b16 v[84:85], v124 offset:33792
    ds_read_b64_tr_b16 v[86:87], v124 offset:34304
    ds_read_b64_tr_b16 v[88:89], v125 offset:33792
    ds_read_b64_tr_b16 v[90:91], v125 offset:34304
    ds_read_b128 v[180:183], v113 offset:12288
    v_mfma_f32_32x32x16_bf16 v[20:35], v[164:167], v[72:75], v[20:35]
    v_mfma_f32_16x16x32_bf16 v[100:103], v[108:111], v[92:95], v[100:103]
    v_mfma_f32_16x16x32_bf16 v[104:107], v[108:111], v[96:99], v[104:107]
    s_add_u32 m0, s59, 3072
    s_add_u32 s69, s56, s62
    buffer_load_dwordx4 v119, s[24:27], s69 offen lds
    s_waitcnt lgkmcnt(6)
    v_mfma_f32_32x32x16_bf16 v[4:19], v[168:171], v[76:79], v[4:19]
    ds_read_b64_tr_b16 v[68:69], v124 offset:36864
    ds_read_b64_tr_b16 v[70:71], v124 offset:37376
    ds_read_b64_tr_b16 v[72:73], v125 offset:36864
    ds_read_b64_tr_b16 v[74:75], v125 offset:37376
    ds_read_b128 v[184:187], v114 offset:12288
    v_mfma_f32_32x32x16_bf16 v[20:35], v[168:171], v[80:83], v[20:35]
    s_add_u32 m0, s55, 65536
    s_add_u32 s69, s82, s96
    s_add_u32 s69, s69, 0
    buffer_load_dwordx4 v0, s[20:23], s69 offen lds
    s_waitcnt lgkmcnt(6)
    v_mfma_f32_32x32x16_bf16 v[4:19], v[172:175], v[84:87], v[4:19]
    ds_read_b64_tr_b16 v[76:77], v124 offset:39936
    ds_read_b64_tr_b16 v[78:79], v124 offset:40448
    ds_read_b64_tr_b16 v[80:81], v125 offset:39936
    ds_read_b64_tr_b16 v[82:83], v125 offset:40448
    ds_read_b128 v[188:191], v115 offset:12288
    v_mfma_f32_32x32x16_bf16 v[20:35], v[172:175], v[88:91], v[20:35]
    s_add_u32 m0, s55, 66560
    s_add_u32 s69, s82, s96
    s_add_u32 s69, s69, 24576
    buffer_load_dwordx4 v0, s[20:23], s69 offen lds
    s_waitcnt lgkmcnt(6)
    v_mfma_f32_32x32x16_bf16 v[4:19], v[176:179], v[68:71], v[4:19]
    ds_read_b64_tr_b16 v[92:93], v126 offset:36864
    ds_read_b64_tr_b16 v[94:95], v126 offset:37376
    ds_read_b64_tr_b16 v[96:97], v127 offset:36864
    ds_read_b64_tr_b16 v[98:99], v127 offset:37376
    ds_read_b64_tr_b16 v[84:85], v124 offset:43008
    ds_read_b64_tr_b16 v[86:87], v124 offset:43520
    ds_read_b64_tr_b16 v[88:89], v125 offset:43008
    ds_read_b64_tr_b16 v[90:91], v125 offset:43520
    v_mfma_f32_32x32x16_bf16 v[20:35], v[176:179], v[72:75], v[20:35]
    s_waitcnt lgkmcnt(4)
    v_mfma_f32_32x32x16_bf16 v[4:19], v[180:183], v[76:79], v[4:19]
    ds_read_b64_tr_b16 v[68:69], v124 offset:46080
    ds_read_b64_tr_b16 v[70:71], v124 offset:46592
    ds_read_b64_tr_b16 v[72:73], v125 offset:46080
    ds_read_b64_tr_b16 v[74:75], v125 offset:46592
    v_mfma_f32_32x32x16_bf16 v[20:35], v[180:183], v[80:83], v[20:35]
    v_mfma_f32_16x16x32_bf16 v[100:103], v[108:111], v[92:95], v[100:103]
    v_mfma_f32_16x16x32_bf16 v[104:107], v[108:111], v[96:99], v[104:107]
    s_waitcnt lgkmcnt(4)
    v_mfma_f32_32x32x16_bf16 v[4:19], v[184:187], v[84:87], v[4:19]
    s_waitcnt vmcnt(2) lgkmcnt(0)
    s_barrier
    ds_read_b64_tr_b16 v[76:77], v124 offset:49152
    ds_read_b64_tr_b16 v[78:79], v124 offset:49664
    ds_read_b64_tr_b16 v[80:81], v125 offset:49152
    ds_read_b64_tr_b16 v[82:83], v125 offset:49664
    ds_read_b128 v[192:195], v112 offset:0
    ds_read_b128 v[196:199], v113 offset:0
    v_mfma_f32_32x32x16_bf16 v[20:35], v[184:187], v[88:91], v[20:35]
    s_add_u32 m0, s59, 8192
    s_add_u32 s69, s56, s63
    buffer_load_dwordx4 v116, s[24:27], s69 offen lds
    v_mfma_f32_32x32x16_bf16 v[4:19], v[188:191], v[68:71], v[4:19]
    ds_read_b64_tr_b16 v[84:85], v124 offset:52224
    ds_read_b64_tr_b16 v[86:87], v124 offset:52736
    ds_read_b64_tr_b16 v[88:89], v125 offset:52224
    ds_read_b64_tr_b16 v[90:91], v125 offset:52736
    ds_read_b128 v[200:203], v114 offset:0
    ds_read_b128 v[204:207], v115 offset:0
    v_mfma_f32_32x32x16_bf16 v[20:35], v[188:191], v[72:75], v[20:35]
    s_add_u32 m0, s59, 9216
    s_add_u32 s69, s56, s63
    buffer_load_dwordx4 v117, s[24:27], s69 offen lds
    s_waitcnt lgkmcnt(7)
    v_mfma_f32_32x32x16_bf16 v[4:19], v[192:195], v[76:79], v[4:19]
    ds_read_b64_tr_b16 v[92:93], v126 offset:49152
    ds_read_b64_tr_b16 v[94:95], v126 offset:49664
    ds_read_b64_tr_b16 v[96:97], v127 offset:49152
    ds_read_b64_tr_b16 v[98:99], v127 offset:49664
    ds_read_b64_tr_b16 v[68:69], v124 offset:55296
    ds_read_b64_tr_b16 v[70:71], v124 offset:55808
    ds_read_b64_tr_b16 v[72:73], v125 offset:55296
    s_waitcnt lgkmcnt(12)
    ds_read_b64_tr_b16 v[74:75], v125 offset:55808
    ds_read_b128 v[208:211], v112 offset:4096
    v_mfma_f32_32x32x16_bf16 v[20:35], v[192:195], v[80:83], v[20:35]
    s_add_u32 m0, s59, 10240
    s_add_u32 s69, s56, s63
    buffer_load_dwordx4 v118, s[24:27], s69 offen lds
    s_waitcnt lgkmcnt(5)
    v_mfma_f32_32x32x16_bf16 v[4:19], v[196:199], v[84:87], v[4:19]
    ds_read_b64_tr_b16 v[76:77], v124 offset:58368
    ds_read_b64_tr_b16 v[78:79], v124 offset:58880
    ds_read_b64_tr_b16 v[80:81], v125 offset:58368
    ds_read_b64_tr_b16 v[82:83], v125 offset:58880
    ds_read_b128 v[212:215], v113 offset:4096
    v_mfma_f32_32x32x16_bf16 v[20:35], v[196:199], v[88:91], v[20:35]
    v_mfma_f32_16x16x32_bf16 v[100:103], v[108:111], v[92:95], v[100:103]
    v_mfma_f32_16x16x32_bf16 v[104:107], v[108:111], v[96:99], v[104:107]
    s_add_u32 m0, s59, 11264
    s_add_u32 s69, s56, s63
    buffer_load_dwordx4 v119, s[24:27], s69 offen lds
    s_waitcnt lgkmcnt(6)
    v_mfma_f32_32x32x16_bf16 v[4:19], v[200:203], v[68:71], v[4:19]
    ds_read_b64_tr_b16 v[84:85], v124 offset:61440
    ds_read_b64_tr_b16 v[86:87], v124 offset:61952
    ds_read_b64_tr_b16 v[88:89], v125 offset:61440
    ds_read_b64_tr_b16 v[90:91], v125 offset:61952
    ds_read_b128 v[216:219], v114 offset:4096
    v_mfma_f32_32x32x16_bf16 v[20:35], v[200:203], v[72:75], v[20:35]
    s_add_u32 m0, s55, 81920
    s_add_u32 s69, s82, s97
    s_add_u32 s69, s69, 0
    buffer_load_dwordx4 v0, s[20:23], s69 offen lds
    s_waitcnt lgkmcnt(6)
    v_mfma_f32_32x32x16_bf16 v[4:19], v[204:207], v[76:79], v[4:19]
    v_add_u32 v124, 0xfc00, v124
    v_add_u32 v125, 0xfc00, v125
    v_add_u32 v126, 0xfc00, v126
    v_add_u32 v127, 0xfc00, v127
    ds_read_b64_tr_b16 v[68:69], v124 offset:0
    ds_read_b64_tr_b16 v[70:71], v124 offset:512
    ds_read_b64_tr_b16 v[72:73], v125 offset:0
    ds_read_b64_tr_b16 v[74:75], v125 offset:512
    ds_read_b128 v[220:223], v115 offset:4096
    v_mfma_f32_32x32x16_bf16 v[20:35], v[204:207], v[80:83], v[20:35]
    s_add_u32 m0, s55, 82944
    s_add_u32 s69, s82, s97
    s_add_u32 s69, s69, 24576
    buffer_load_dwordx4 v0, s[20:23], s69 offen lds
    s_waitcnt lgkmcnt(6)
    v_mfma_f32_32x32x16_bf16 v[4:19], v[208:211], v[84:87], v[4:19]
    v_add_u32 v124, 0xfffff400, v124
    v_add_u32 v125, 0xfffff400, v125
    v_add_u32 v126, 0xfffff400, v126
    v_add_u32 v127, 0xfffff400, v127
    ds_read_b64_tr_b16 v[92:93], v126 offset:0
    ds_read_b64_tr_b16 v[94:95], v126 offset:512
    ds_read_b64_tr_b16 v[96:97], v127 offset:0
    ds_read_b64_tr_b16 v[98:99], v127 offset:512
    ds_read_b64_tr_b16 v[76:77], v124 offset:6144
    ds_read_b64_tr_b16 v[78:79], v124 offset:6656
    ds_read_b64_tr_b16 v[80:81], v125 offset:6144
    ds_read_b64_tr_b16 v[82:83], v125 offset:6656
    v_mfma_f32_32x32x16_bf16 v[20:35], v[208:211], v[88:91], v[20:35]
    s_add_u32 m0, s55, 98304
    s_add_u32 s69, s82, s98
    s_add_u32 s69, s69, 0
    buffer_load_dwordx4 v0, s[20:23], s69 offen lds
    s_waitcnt lgkmcnt(4)
    v_mfma_f32_32x32x16_bf16 v[4:19], v[212:215], v[68:71], v[4:19]
    ds_read_b64_tr_b16 v[84:85], v124 offset:9216
    ds_read_b64_tr_b16 v[86:87], v124 offset:9728
    ds_read_b64_tr_b16 v[88:89], v125 offset:9216
    ds_read_b64_tr_b16 v[90:91], v125 offset:9728
    v_mfma_f32_32x32x16_bf16 v[20:35], v[212:215], v[72:75], v[20:35]
    v_mfma_f32_16x16x32_bf16 v[100:103], v[108:111], v[92:95], v[100:103]
    v_mfma_f32_16x16x32_bf16 v[104:107], v[108:111], v[96:99], v[104:107]
    s_add_u32 m0, s55, 99328
    s_add_u32 s69, s82, s98
    s_add_u32 s69, s69, 24576
    buffer_load_dwordx4 v0, s[20:23], s69 offen lds
    s_waitcnt lgkmcnt(4)
    v_mfma_f32_32x32x16_bf16 v[4:19], v[216:219], v[76:79], v[4:19]
    s_waitcnt vmcnt(4) lgkmcnt(0)
    s_barrier
    ds_read_b64_tr_b16 v[68:69], v124 offset:12288
    ds_read_b64_tr_b16 v[70:71], v124 offset:12800
    ds_read_b64_tr_b16 v[72:73], v125 offset:12288
    ds_read_b64_tr_b16 v[74:75], v125 offset:12800
    ds_read_b128 v[224:227], v112 offset:8192
    ds_read_b128 v[228:231], v113 offset:8192
    v_mfma_f32_32x32x16_bf16 v[20:35], v[216:219], v[80:83], v[20:35]
    s_add_u32 m0, s55, 114688
    s_add_u32 s69, s82, s99
    s_add_u32 s69, s69, 0
    buffer_load_dwordx4 v0, s[20:23], s69 offen lds
    v_mfma_f32_32x32x16_bf16 v[4:19], v[220:223], v[84:87], v[4:19]
    ds_read_b64_tr_b16 v[76:77], v124 offset:15360
    ds_read_b64_tr_b16 v[78:79], v124 offset:15872
    ds_read_b64_tr_b16 v[80:81], v125 offset:15360
    ds_read_b64_tr_b16 v[82:83], v125 offset:15872
    ds_read_b128 v[232:235], v114 offset:8192
    ds_read_b128 v[236:239], v115 offset:8192
    v_mfma_f32_32x32x16_bf16 v[20:35], v[220:223], v[88:91], v[20:35]
    s_add_u32 m0, s55, 115712
    s_add_u32 s69, s82, s99
    s_add_u32 s69, s69, 24576
    buffer_load_dwordx4 v0, s[20:23], s69 offen lds
    s_waitcnt lgkmcnt(7)
    v_mfma_f32_32x32x16_bf16 v[4:19], v[224:227], v[68:71], v[4:19]
    ds_read_b64_tr_b16 v[92:93], v126 offset:12288
    ds_read_b64_tr_b16 v[94:95], v126 offset:12800
    ds_read_b64_tr_b16 v[96:97], v127 offset:12288
    ds_read_b64_tr_b16 v[98:99], v127 offset:12800
    ds_read_b64_tr_b16 v[84:85], v124 offset:18432
    ds_read_b64_tr_b16 v[86:87], v124 offset:18944
    ds_read_b64_tr_b16 v[88:89], v125 offset:18432
    s_waitcnt lgkmcnt(12)
    ds_read_b64_tr_b16 v[90:91], v125 offset:18944
    ds_read_b128 v[240:243], v112 offset:12288
    v_mfma_f32_32x32x16_bf16 v[20:35], v[224:227], v[72:75], v[20:35]
    s_waitcnt lgkmcnt(5)
    v_mfma_f32_32x32x16_bf16 v[4:19], v[228:231], v[76:79], v[4:19]
    ds_read_b64_tr_b16 v[68:69], v124 offset:21504
    ds_read_b64_tr_b16 v[70:71], v124 offset:22016
    ds_read_b64_tr_b16 v[72:73], v125 offset:21504
    ds_read_b64_tr_b16 v[74:75], v125 offset:22016
    ds_read_b128 v[244:247], v113 offset:12288
    v_mfma_f32_32x32x16_bf16 v[20:35], v[228:231], v[80:83], v[20:35]
    v_mfma_f32_16x16x32_bf16 v[100:103], v[108:111], v[92:95], v[100:103]
    v_mfma_f32_16x16x32_bf16 v[104:107], v[108:111], v[96:99], v[104:107]
    s_waitcnt lgkmcnt(6)
    v_mfma_f32_32x32x16_bf16 v[4:19], v[232:235], v[84:87], v[4:19]
    ds_read_b64_tr_b16 v[76:77], v124 offset:24576
    ds_read_b64_tr_b16 v[78:79], v124 offset:25088
    ds_read_b64_tr_b16 v[80:81], v125 offset:24576
    ds_read_b64_tr_b16 v[82:83], v125 offset:25088
    ds_read_b128 v[248:251], v114 offset:12288
    v_mfma_f32_32x32x16_bf16 v[20:35], v[232:235], v[88:91], v[20:35]
    buffer_load_dword v37, off, s[44:47], 0 sc1
    s_waitcnt lgkmcnt(6)
    v_mfma_f32_32x32x16_bf16 v[4:19], v[236:239], v[68:71], v[4:19]
    ds_read_b64_tr_b16 v[84:85], v124 offset:27648
    ds_read_b64_tr_b16 v[86:87], v124 offset:28160
    ds_read_b64_tr_b16 v[88:89], v125 offset:27648
    ds_read_b64_tr_b16 v[90:91], v125 offset:28160
    ds_read_b128 v[252:255], v115 offset:12288
    v_mfma_f32_32x32x16_bf16 v[20:35], v[236:239], v[72:75], v[20:35]
    s_waitcnt lgkmcnt(6)
    v_mfma_f32_32x32x16_bf16 v[4:19], v[240:243], v[76:79], v[4:19]
    ds_read_b64_tr_b16 v[92:93], v126 offset:24576
    ds_read_b64_tr_b16 v[94:95], v126 offset:25088
    ds_read_b64_tr_b16 v[96:97], v127 offset:24576
    ds_read_b64_tr_b16 v[98:99], v127 offset:25088
    ds_read_b64_tr_b16 v[68:69], v124 offset:30720
    ds_read_b64_tr_b16 v[70:71], v124 offset:31232
    ds_read_b64_tr_b16 v[72:73], v125 offset:30720
    ds_read_b64_tr_b16 v[74:75], v125 offset:31232
    v_mfma_f32_32x32x16_bf16 v[20:35], v[240:243], v[80:83], v[20:35]
    s_waitcnt lgkmcnt(4)
    v_mfma_f32_32x32x16_bf16 v[4:19], v[244:247], v[84:87], v[4:19]
    ds_read_b64_tr_b16 v[76:77], v124 offset:33792
    ds_read_b64_tr_b16 v[78:79], v124 offset:34304
    ds_read_b64_tr_b16 v[80:81], v125 offset:33792
    ds_read_b64_tr_b16 v[82:83], v125 offset:34304
    v_mfma_f32_32x32x16_bf16 v[20:35], v[244:247], v[88:91], v[20:35]
    v_mfma_f32_16x16x32_bf16 v[100:103], v[108:111], v[92:95], v[100:103]
    v_mfma_f32_16x16x32_bf16 v[104:107], v[108:111], v[96:99], v[104:107]
    s_waitcnt lgkmcnt(4)
    v_mfma_f32_32x32x16_bf16 v[4:19], v[248:251], v[68:71], v[4:19]
    v_mfma_f32_32x32x16_bf16 v[20:35], v[248:251], v[72:75], v[20:35]
    v_lshl_add_u32 v3, v1, 2, s9
    s_nop 2
    ds_write_b32 v3, v100 offset:256
    ds_write_b32 v3, v104 offset:512
    s_waitcnt lgkmcnt(2)
    v_mfma_f32_32x32x16_bf16 v[4:19], v[252:255], v[76:79], v[4:19]
    v_mfma_f32_32x32x16_bf16 v[20:35], v[252:255], v[80:83], v[20:35]
    v_mov_b32 v2, 0
    v_lshlrev_b32 v3, 2, v1
    ds_write_b32 v3, v2
    s_waitcnt vmcnt(0) lgkmcnt(0)
    s_barrier
    s_setprio 0
    v_lshl_add_u32 v3, v1, 2, s9
    ds_read_b32 v84, v3 offset:2048
    ds_read_b32 v88, v3 offset:2304
    v_lshlrev_b32 v2, 2, v1
    ds_read_b32 v68, v2 offset:256
    ds_read_b32 v69, v2 offset:4352
    ds_read_b32 v70, v2 offset:16640
    ds_read_b32 v71, v2 offset:20736
    ds_read_b32 v72, v2 offset:512
    ds_read_b32 v73, v2 offset:4608
    ds_read_b32 v74, v2 offset:16896
    ds_read_b32 v75, v2 offset:20992
    v_readfirstlane_b32 s11, v37
    s_nop 0
    s_cmp_lg_u32 s11, 0
    s_cbranch_scc1 L_pa_tagb
    s_mov_b32 s34, 0
L_pa_tagpb:
    buffer_load_dword v2, off, s[44:47], 0 sc1
    s_add_u32 s34, s34, 1
    s_waitcnt vmcnt(0)
    v_readfirstlane_b32 s11, v2
    s_cmp_gt_u32 s34, 0x10000
    s_cbranch_scc1 L_pa_tagb
    s_cmp_eq_u32 s11, 0
    s_cbranch_scc1 L_pa_tagpb
L_pa_tagb:
    s_add_u32 m0, s55, 131072
    s_add_u32 s69, s80, s64
    s_add_u32 s69, s69, 0
    buffer_load_dwordx4 v121, s[16:19], s69 offen lds
    s_add_u32 m0, s55, 132096
    s_add_u32 s69, s80, s64
    s_add_u32 s69, s69, 28672
    buffer_load_dwordx4 v121, s[16:19], s69 offen lds
    s_add_u32 m0, s55, 147456
    s_add_u32 s69, s80, s65
    s_add_u32 s69, s69, 0
    buffer_load_dwordx4 v121, s[16:19], s69 offen lds
    s_add_u32 m0, s55, 148480
    s_add_u32 s69, s80, s65
    s_add_u32 s69, s69, 28672
    buffer_load_dwordx4 v121, s[16:19], s69 offen lds
    s_add_u32 m0, s55, 32768
    s_add_u32 s69, s80, s66
    s_add_u32 s69, s69, 0
    buffer_load_dwordx4 v121, s[16:19], s69 offen lds
    s_add_u32 m0, s55, 33792
    s_add_u32 s69, s80, s66
    s_add_u32 s69, s69, 28672
    buffer_load_dwordx4 v121, s[16:19], s69 offen lds
    s_add_u32 m0, s55, 49152
    s_add_u32 s69, s80, s67
    s_add_u32 s69, s69, 0
    buffer_load_dwordx4 v121, s[16:19], s69 offen lds
    s_add_u32 m0, s55, 50176
    s_add_u32 s69, s80, s67
    s_add_u32 s69, s69, 28672
    buffer_load_dwordx4 v121, s[16:19], s69 offen lds
    s_waitcnt lgkmcnt(8)
    v_mov_b32 v122, v88
    v_mul_f32 v84, 0x3b000000, v84
    v_cndmask_b32 v85, v84, 0, s[74:75]
    v_mul_f32 v86, v84, v84
    v_cvt_pk_bf16_f32 v112, v85, v85
    v_fma_f32 v122, v122, s76, -v86
    v_and_b32 v87, 0xffff0000, v112
    v_max_f32 v122, 0, v122
    v_sub_f32 v87, v85, v87
    v_add_f32 v122, 0x3727c5ac, v122
    v_cvt_pk_bf16_f32 v113, v87, 0
    v_rsq_f32 v116, v122
    v_mov_b32 v114, 0
    v_mov_b32 v115, 0
    v_lshl_add_u32 v3, v123, 2, s9
    ds_write_b32 v3, v116 offset:2560
    v_lshrrev_b32 v3, 5, v1
    v_lshl_add_u32 v3, v3, 5, s9
    s_waitcnt lgkmcnt(0)
    ds_read_b128 v[52:55], v3 offset:2560
    ds_read_b128 v[56:59], v3 offset:2576
    ds_read_b128 v[60:63], v3 offset:2624
    ds_read_b128 v[64:67], v3 offset:2640
    v_mov_b32 v118, 0xc0135761
    v_mov_b32 v94, 0
    v_mov_b32 v95, 0
    v_add_f32 v68, v68, v69
    v_add_f32 v70, v70, v71
    v_add_f32 v68, v68, v70
    v_sub_f32 v68, 0, v68
    v_cvt_pk_bf16_f32 v93, v68, 0
    v_lshlrev_b32 v69, 16, v93
    v_sub_f32 v69, v68, v69
    v_cvt_pk_bf16_f32 v92, v68, v69
    s_nop 1
    v_mfma_f32_32x32x16_bf16 v[4:19], v[112:115], v[92:95], v[4:19]
    v_add_f32 v72, v72, v73
    v_add_f32 v74, v74, v75
    v_add_f32 v72, v72, v74
    v_sub_f32 v72, 0, v72
    v_cvt_pk_bf16_f32 v93, v72, 0
    v_lshlrev_b32 v73, 16, v93
    v_sub_f32 v73, v72, v73
    v_cvt_pk_bf16_f32 v92, v72, v73
    s_nop 1
    v_mfma_f32_32x32x16_bf16 v[20:35], v[112:115], v[92:95], v[20:35]
    s_waitcnt lgkmcnt(0)
    v_mul_f32 v4, v4, v52
    v_mul_f32 v5, v5, v53
    v_mul_f32 v6, v6, v54
    v_mul_f32 v7, v7, v55
    v_mul_f32 v68, v4, v4
    v_mul_f32 v69, v5, v5
    v_mul_f32 v70, v6, v6
    v_mul_f32 v71, v7, v7
    v_fma_f32 v68, v68, s77, v118
    v_fma_f32 v69, v69, s77, v118
    v_fma_f32 v70, v70, s77, v118
    v_fma_f32 v71, v71, s77, v118
    v_mul_f32 v68, v68, v4
    v_mul_f32 v69, v69, v5
    v_mul_f32 v70, v70, v6
    v_mul_f32 v71, v71, v7
    v_exp_f32 v68, v68
    v_exp_f32 v69, v69
    v_exp_f32 v70, v70
    v_exp_f32 v71, v71
    v_add_f32 v68, 1.0, v68
    v_add_f32 v69, 1.0, v69
    v_add_f32 v70, 1.0, v70
    v_add_f32 v71, 1.0, v71
    v_rcp_f32 v68, v68
    v_rcp_f32 v69, v69
    v_rcp_f32 v70, v70
    v_rcp_f32 v71, v71
    v_mul_f32 v4, v4, v68
    v_mul_f32 v5, v5, v69
    v_mul_f32 v6, v6, v70
    v_mul_f32 v7, v7, v71
    v_mul_f32 v8, v8, v56
    v_mul_f32 v9, v9, v57
    v_mul_f32 v10, v10, v58
    v_mul_f32 v11, v11, v59
    v_mul_f32 v68, v8, v8
    v_mul_f32 v69, v9, v9
    v_mul_f32 v70, v10, v10
    v_mul_f32 v71, v11, v11
    v_fma_f32 v68, v68, s77, v118
    v_fma_f32 v69, v69, s77, v118
    v_fma_f32 v70, v70, s77, v118
    v_fma_f32 v71, v71, s77, v118
    v_mul_f32 v68, v68, v8
    v_mul_f32 v69, v69, v9
    v_mul_f32 v70, v70, v10
    v_mul_f32 v71, v71, v11
    v_exp_f32 v68, v68
    v_exp_f32 v69, v69
    v_exp_f32 v70, v70
    v_exp_f32 v71, v71
    v_add_f32 v68, 1.0, v68
    v_add_f32 v69, 1.0, v69
    v_add_f32 v70, 1.0, v70
    v_add_f32 v71, 1.0, v71
    v_rcp_f32 v68, v68
    v_rcp_f32 v69, v69
    v_rcp_f32 v70, v70
    v_rcp_f32 v71, v71
    v_mul_f32 v8, v8, v68
    v_mul_f32 v9, v9, v69
    v_mul_f32 v10, v10, v70
    v_mul_f32 v11, v11, v71
    v_mul_f32 v12, v12, v60
    v_mul_f32 v13, v13, v61
    v_mul_f32 v14, v14, v62
    v_mul_f32 v15, v15, v63
    v_mul_f32 v68, v12, v12
    v_mul_f32 v69, v13, v13
    v_mul_f32 v70, v14, v14
    v_mul_f32 v71, v15, v15
    v_fma_f32 v68, v68, s77, v118
    v_fma_f32 v69, v69, s77, v118
    v_fma_f32 v70, v70, s77, v118
    v_fma_f32 v71, v71, s77, v118
    v_mul_f32 v68, v68, v12
    v_mul_f32 v69, v69, v13
    v_mul_f32 v70, v70, v14
    v_mul_f32 v71, v71, v15
    v_exp_f32 v68, v68
    v_exp_f32 v69, v69
    v_exp_f32 v70, v70
    v_exp_f32 v71, v71
    v_add_f32 v68, 1.0, v68
    v_add_f32 v69, 1.0, v69
    v_add_f32 v70, 1.0, v70
    v_add_f32 v71, 1.0, v71
    v_rcp_f32 v68, v68
    v_rcp_f32 v69, v69
    v_rcp_f32 v70, v70
    v_rcp_f32 v71, v71
    v_mul_f32 v12, v12, v68
    v_mul_f32 v13, v13, v69
    v_mul_f32 v14, v14, v70
    v_mul_f32 v15, v15, v71
    v_mul_f32 v16, v16, v64
    v_mul_f32 v17, v17, v65
    v_mul_f32 v18, v18, v66
    v_mul_f32 v19, v19, v67
    v_mul_f32 v68, v16, v16
    v_mul_f32 v69, v17, v17
    v_mul_f32 v70, v18, v18
    v_mul_f32 v71, v19, v19
    v_fma_f32 v68, v68, s77, v118
    v_fma_f32 v69, v69, s77, v118
    v_fma_f32 v70, v70, s77, v118
    v_fma_f32 v71, v71, s77, v118
    v_mul_f32 v68, v68, v16
    v_mul_f32 v69, v69, v17
    v_mul_f32 v70, v70, v18
    v_mul_f32 v71, v71, v19
    v_exp_f32 v68, v68
    v_exp_f32 v69, v69
    v_exp_f32 v70, v70
    v_exp_f32 v71, v71
    v_add_f32 v68, 1.0, v68
    v_add_f32 v69, 1.0, v69
    v_add_f32 v70, 1.0, v70
    v_add_f32 v71, 1.0, v71
    v_rcp_f32 v68, v68
    v_rcp_f32 v69, v69
    v_rcp_f32 v70, v70
    v_rcp_f32 v71, v71
    v_mul_f32 v16, v16, v68
    v_mul_f32 v17, v17, v69
    v_mul_f32 v18, v18, v70
    v_mul_f32 v19, v19, v71
    v_mul_f32 v20, v20, v52
    v_mul_f32 v21, v21, v53
    v_mul_f32 v22, v22, v54
    v_mul_f32 v23, v23, v55
    v_mul_f32 v68, v20, v20
    v_mul_f32 v69, v21, v21
    v_mul_f32 v70, v22, v22
    v_mul_f32 v71, v23, v23
    v_fma_f32 v68, v68, s77, v118
    v_fma_f32 v69, v69, s77, v118
    v_fma_f32 v70, v70, s77, v118
    v_fma_f32 v71, v71, s77, v118
    v_mul_f32 v68, v68, v20
    v_mul_f32 v69, v69, v21
    v_mul_f32 v70, v70, v22
    v_mul_f32 v71, v71, v23
    v_exp_f32 v68, v68
    v_exp_f32 v69, v69
    v_exp_f32 v70, v70
    v_exp_f32 v71, v71
    v_add_f32 v68, 1.0, v68
    v_add_f32 v69, 1.0, v69
    v_add_f32 v70, 1.0, v70
    v_add_f32 v71, 1.0, v71
    v_rcp_f32 v68, v68
    v_rcp_f32 v69, v69
    v_rcp_f32 v70, v70
    v_rcp_f32 v71, v71
    v_mul_f32 v20, v20, v68
    v_mul_f32 v21, v21, v69
    v_mul_f32 v22, v22, v70
    v_mul_f32 v23, v23, v71
    v_mul_f32 v24, v24, v56
    v_mul_f32 v25, v25, v57
    v_mul_f32 v26, v26, v58
    v_mul_f32 v27, v27, v59
    v_mul_f32 v68, v24, v24
    v_mul_f32 v69, v25, v25
    v_mul_f32 v70, v26, v26
    v_mul_f32 v71, v27, v27
    v_fma_f32 v68, v68, s77, v118
    v_fma_f32 v69, v69, s77, v118
    v_fma_f32 v70, v70, s77, v118
    v_fma_f32 v71, v71, s77, v118
    v_mul_f32 v68, v68, v24
    v_mul_f32 v69, v69, v25
    v_mul_f32 v70, v70, v26
    v_mul_f32 v71, v71, v27
    v_exp_f32 v68, v68
    v_exp_f32 v69, v69
    v_exp_f32 v70, v70
    v_exp_f32 v71, v71
    v_add_f32 v68, 1.0, v68
    v_add_f32 v69, 1.0, v69
    v_add_f32 v70, 1.0, v70
    v_add_f32 v71, 1.0, v71
    v_rcp_f32 v68, v68
    v_rcp_f32 v69, v69
    v_rcp_f32 v70, v70
    v_rcp_f32 v71, v71
    v_mul_f32 v24, v24, v68
    v_mul_f32 v25, v25, v69
    v_mul_f32 v26, v26, v70
    v_mul_f32 v27, v27, v71
    v_mul_f32 v28, v28, v60
    v_mul_f32 v29, v29, v61
    v_mul_f32 v30, v30, v62
    v_mul_f32 v31, v31, v63
    v_mul_f32 v68, v28, v28
    v_mul_f32 v69, v29, v29
    v_mul_f32 v70, v30, v30
    v_mul_f32 v71, v31, v31
    v_fma_f32 v68, v68, s77, v118
    v_fma_f32 v69, v69, s77, v118
    v_fma_f32 v70, v70, s77, v118
    v_fma_f32 v71, v71, s77, v118
    v_mul_f32 v68, v68, v28
    v_mul_f32 v69, v69, v29
    v_mul_f32 v70, v70, v30
    v_mul_f32 v71, v71, v31
    v_exp_f32 v68, v68
    v_exp_f32 v69, v69
    v_exp_f32 v70, v70
    v_exp_f32 v71, v71
    v_add_f32 v68, 1.0, v68
    v_add_f32 v69, 1.0, v69
    v_add_f32 v70, 1.0, v70
    v_add_f32 v71, 1.0, v71
    v_rcp_f32 v68, v68
    v_rcp_f32 v69, v69
    v_rcp_f32 v70, v70
    v_rcp_f32 v71, v71
    v_mul_f32 v28, v28, v68
    v_mul_f32 v29, v29, v69
    v_mul_f32 v30, v30, v70
    v_mul_f32 v31, v31, v71
    v_mul_f32 v32, v32, v64
    v_mul_f32 v33, v33, v65
    v_mul_f32 v34, v34, v66
    v_mul_f32 v35, v35, v67
    v_mul_f32 v68, v32, v32
    v_mul_f32 v69, v33, v33
    v_mul_f32 v70, v34, v34
    v_mul_f32 v71, v35, v35
    v_fma_f32 v68, v68, s77, v118
    v_fma_f32 v69, v69, s77, v118
    v_fma_f32 v70, v70, s77, v118
    v_fma_f32 v71, v71, s77, v118
    v_mul_f32 v68, v68, v32
    v_mul_f32 v69, v69, v33
    v_mul_f32 v70, v70, v34
    v_mul_f32 v71, v71, v35
    v_exp_f32 v68, v68
    v_exp_f32 v69, v69
    v_exp_f32 v70, v70
    v_exp_f32 v71, v71
    v_add_f32 v68, 1.0, v68
    v_add_f32 v69, 1.0, v69
    v_add_f32 v70, 1.0, v70
    v_add_f32 v71, 1.0, v71
    v_rcp_f32 v68, v68
    v_rcp_f32 v69, v69
    v_rcp_f32 v70, v70
    v_rcp_f32 v71, v71
    v_mul_f32 v32, v32, v68
    v_mul_f32 v33, v33, v69
    v_mul_f32 v34, v34, v70
    v_mul_f32 v35, v35, v71
    v_mul_f32 v80, v4, v4
    v_add_f32 v72, v4, v20
    v_mul_f32 v81, v5, v5
    v_add_f32 v73, v5, v21
    v_mul_f32 v82, v6, v6
    v_add_f32 v74, v6, v22
    v_mul_f32 v83, v7, v7
    v_add_f32 v75, v7, v23
    v_mul_f32 v84, v8, v8
    v_add_f32 v76, v8, v24
    v_mul_f32 v85, v9, v9
    v_add_f32 v77, v9, v25
    v_mul_f32 v86, v10, v10
    v_add_f32 v78, v10, v26
    v_mul_f32 v87, v11, v11
    v_add_f32 v79, v11, v27
    v_fmac_f32 v80, v20, v20
    v_fmac_f32 v81, v21, v21
    v_fmac_f32 v82, v22, v22
    v_fmac_f32 v83, v23, v23
    v_fmac_f32 v84, v24, v24
    v_fmac_f32 v85, v25, v25
    v_fmac_f32 v86, v26, v26
    v_fmac_f32 v87, v27, v27
    v_permlane16_swap_b32 v72, v76
    v_permlane16_swap_b32 v73, v77
    v_permlane16_swap_b32 v74, v78
    v_permlane16_swap_b32 v75, v79
    v_permlane16_swap_b32 v80, v84
    v_permlane16_swap_b32 v81, v85
    v_permlane16_swap_b32 v82, v86
    v_permlane16_swap_b32 v83, v87
    v_add_f32 v72, v72, v76
    v_add_f32 v73, v73, v77
    v_add_f32 v74, v74, v78
    v_add_f32 v75, v75, v79
    v_add_f32 v80, v80, v84
    v_add_f32 v81, v81, v85
    v_add_f32 v82, v82, v86
    v_add_f32 v83, v83, v87
    v_add_f32_dpp v76, v72, v72 row_ror:8 row_mask:0xf bank_mask:0x3
    v_add_f32_dpp v77, v73, v73 row_ror:8 row_mask:0xf bank_mask:0x3
    v_add_f32_dpp v84, v80, v80 row_ror:8 row_mask:0xf bank_mask:0x3
    v_add_f32_dpp v85, v81, v81 row_ror:8 row_mask:0xf bank_mask:0x3
    v_add_f32_dpp v76, v74, v74 row_ror:8 row_mask:0xf bank_mask:0xc
    v_add_f32_dpp v77, v75, v75 row_ror:8 row_mask:0xf bank_mask:0xc
    v_add_f32_dpp v84, v82, v82 row_ror:8 row_mask:0xf bank_mask:0xc
    v_add_f32_dpp v85, v83, v83 row_ror:8 row_mask:0xf bank_mask:0xc
    v_add_f32_dpp v72, v76, v76 row_half_mirror row_mask:0xf bank_mask:0x5
    v_add_f32_dpp v80, v84, v84 row_half_mirror row_mask:0xf bank_mask:0x5
    s_nop 0
    v_add_f32_dpp v72, v77, v77 row_half_mirror row_mask:0xf bank_mask:0xa
    v_add_f32_dpp v80, v85, v85 row_half_mirror row_mask:0xf bank_mask:0xa
    s_nop 0
    v_add_f32_dpp v72, v72, v72 quad_perm:[1,0,3,2] row_mask:0xf bank_mask:0xf
    v_add_f32_dpp v80, v80, v80 quad_perm:[1,0,3,2] row_mask:0xf bank_mask:0xf
    s_nop 0
    v_add_f32_dpp v96, v72, v72 quad_perm:[2,3,0,1] row_mask:0xf bank_mask:0xf
    v_add_f32_dpp v97, v80, v80 quad_perm:[2,3,0,1] row_mask:0xf bank_mask:0xf
    v_mul_f32 v80, v12, v12
    v_add_f32 v72, v12, v28
    v_mul_f32 v81, v13, v13
    v_add_f32 v73, v13, v29
    v_mul_f32 v82, v14, v14
    v_add_f32 v74, v14, v30
    v_mul_f32 v83, v15, v15
    v_add_f32 v75, v15, v31
    v_mul_f32 v84, v16, v16
    v_add_f32 v76, v16, v32
    v_mul_f32 v85, v17, v17
    v_add_f32 v77, v17, v33
    v_mul_f32 v86, v18, v18
    v_add_f32 v78, v18, v34
    v_mul_f32 v87, v19, v19
    v_add_f32 v79, v19, v35
    v_fmac_f32 v80, v28, v28
    v_fmac_f32 v81, v29, v29
    v_fmac_f32 v82, v30, v30
    v_fmac_f32 v83, v31, v31
    v_fmac_f32 v84, v32, v32
    v_fmac_f32 v85, v33, v33
    v_fmac_f32 v86, v34, v34
    v_fmac_f32 v87, v35, v35
    v_permlane16_swap_b32 v72, v76
    v_permlane16_swap_b32 v73, v77
    v_permlane16_swap_b32 v74, v78
    v_permlane16_swap_b32 v75, v79
    v_permlane16_swap_b32 v80, v84
    v_permlane16_swap_b32 v81, v85
    v_permlane16_swap_b32 v82, v86
    v_permlane16_swap_b32 v83, v87
    v_add_f32 v72, v72, v76
    v_add_f32 v73, v73, v77
    v_add_f32 v74, v74, v78
    v_add_f32 v75, v75, v79
    v_add_f32 v80, v80, v84
    v_add_f32 v81, v81, v85
    v_add_f32 v82, v82, v86
    v_add_f32 v83, v83, v87
    v_add_f32_dpp v76, v72, v72 row_ror:8 row_mask:0xf bank_mask:0x3
    v_add_f32_dpp v77, v73, v73 row_ror:8 row_mask:0xf bank_mask:0x3
    v_add_f32_dpp v84, v80, v80 row_ror:8 row_mask:0xf bank_mask:0x3
    v_add_f32_dpp v85, v81, v81 row_ror:8 row_mask:0xf bank_mask:0x3
    v_add_f32_dpp v76, v74, v74 row_ror:8 row_mask:0xf bank_mask:0xc
    v_add_f32_dpp v77, v75, v75 row_ror:8 row_mask:0xf bank_mask:0xc
    v_add_f32_dpp v84, v82, v82 row_ror:8 row_mask:0xf bank_mask:0xc
    v_add_f32_dpp v85, v83, v83 row_ror:8 row_mask:0xf bank_mask:0xc
    v_add_f32_dpp v72, v76, v76 row_half_mirror row_mask:0xf bank_mask:0x5
    v_add_f32_dpp v80, v84, v84 row_half_mirror row_mask:0xf bank_mask:0x5
    s_nop 0
    v_add_f32_dpp v72, v77, v77 row_half_mirror row_mask:0xf bank_mask:0xa
    v_add_f32_dpp v80, v85, v85 row_half_mirror row_mask:0xf bank_mask:0xa
    s_nop 0
    v_add_f32_dpp v72, v72, v72 quad_perm:[1,0,3,2] row_mask:0xf bank_mask:0xf
    v_add_f32_dpp v80, v80, v80 quad_perm:[1,0,3,2] row_mask:0xf bank_mask:0xf
    s_nop 0
    v_add_f32_dpp v98, v72, v72 quad_perm:[2,3,0,1] row_mask:0xf bank_mask:0xf
    v_add_f32_dpp v99, v80, v80 quad_perm:[2,3,0,1] row_mask:0xf bank_mask:0xf
    s_waitcnt vmcnt(0)
    v_and_b32 v3, 1, v1
    v_cmp_eq_u32 vcc, 1, v3
    v_bfe_u32 v2, v1, 2, 1
    v_lshl_add_u32 v2, v3, 4, v2
    v_bfe_u32 v3, v1, 3, 1
    v_lshl_add_u32 v2, v3, 1, v2
    v_bfe_u32 v3, v1, 4, 2
    v_lshl_add_u32 v2, v3, 2, v2
    v_lshlrev_b32 v2, 4, v2
    v_cndmask_b32 v96, v96, v98, vcc
    v_cndmask_b32 v98, v97, v99, vcc
    v_mov_b32 v97, s11
    v_mov_b32 v99, s11
    buffer_store_dwordx4 v[96:99], v2, s[40:43], s88 offen sc1
    v_sqrt_f32 v117, v122
    v_mul_f32 v118, 0xc0135761, v116
    v_mul_f32 v119, v116, v116
    v_mul_f32 v119, v119, v118
    v_mul_f32 v119, 0x3d372713, v119
    s_lshl_b32 s34, s29, 2
    v_mov_b32 v123, s34
    v_lshrrev_b32 v2, 5, v1
    v_lshlrev_b32 v124, 10, v2
    v_bfe_u32 v3, v1, 2, 2
    v_lshl_add_u32 v124, v3, 7, v124
    v_bfe_u32 v3, v1, 4, 1
    v_lshl_add_u32 v124, v3, 5, v124
    v_and_b32 v3, 1, v1
    v_lshl_add_u32 v124, v3, 4, v124
    v_bfe_u32 v3, v1, 1, 1
    v_lshl_add_u32 v124, v3, 3, v124
    v_bfe_u32 v3, v1, 3, 1
    v_lshl_add_u32 v124, v3, 6, v124
    v_add_u32 v124, 131072, v124
    s_mul_i32 s34, s29, 2048
    v_xor_b32 v125, 64, v124
    v_add_u32 v126, s34, v124
    v_add_u32 v127, s34, v125
    s_waitcnt lgkmcnt(0)
    s_barrier
    s_setprio 2
    s_mov_b32 s88, s32
    s_mov_b32 s89, 0x7ff00000
    s_cmp_ge_u32 s32, 14
    s_cbranch_scc1 L_pa_b_done
    ds_read_b64_tr_b16 v[68:69], v124 offset:0
    ds_read_b64_tr_b16 v[70:71], v124 offset:512
    ds_read_b64_tr_b16 v[72:73], v125 offset:0
    ds_read_b64_tr_b16 v[74:75], v125 offset:512
    ds_read_b64_tr_b16 v[76:77], v124 offset:2048
    ds_read_b64_tr_b16 v[78:79], v124 offset:2560
    ds_read_b64_tr_b16 v[80:81], v125 offset:2048
    ds_read_b64_tr_b16 v[82:83], v125 offset:2560
    s_waitcnt lgkmcnt(4)
    v_mfma_f32_32x32x16_bf16 v[36:51], v[68:71], v[128:131], 0
    ds_read_b64_tr_b16 v[92:93], v126 offset:0
    ds_read_b64_tr_b16 v[94:95], v126 offset:512
    ds_read_b64_tr_b16 v[96:97], v127 offset:0
    ds_read_b64_tr_b16 v[98:99], v127 offset:512
    ds_read_b64_tr_b16 v[84:85], v124 offset:4096
    ds_read_b64_tr_b16 v[86:87], v124 offset:4608
    ds_read_b64_tr_b16 v[88:89], v125 offset:4096
    ds_read_b64_tr_b16 v[90:91], v125 offset:4608
    v_mfma_f32_32x32x16_bf16 v[52:67], v[72:75], v[128:131], 0
    s_waitcnt lgkmcnt(4)
    v_mfma_f32_32x32x16_bf16 v[36:51], v[76:79], v[132:135], v[36:51]
    ds_read_b64_tr_b16 v[68:69], v124 offset:6144
    ds_read_b64_tr_b16 v[70:71], v124 offset:6656
    ds_read_b64_tr_b16 v[72:73], v125 offset:6144
    ds_read_b64_tr_b16 v[74:75], v125 offset:6656
    v_mfma_f32_32x32x16_bf16 v[52:67], v[80:83], v[132:135], v[52:67]
    v_mfma_f32_16x16x32_bf16 v[100:103], v[108:111], v[92:95], 0
    v_mfma_f32_16x16x32_bf16 v[104:107], v[108:111], v[96:99], 0
    s_waitcnt lgkmcnt(4)
    v_mfma_f32_32x32x16_bf16 v[36:51], v[84:87], v[136:139], v[36:51]
    ds_read_b64_tr_b16 v[76:77], v124 offset:8192
    ds_read_b64_tr_b16 v[78:79], v124 offset:8704
    ds_read_b64_tr_b16 v[80:81], v125 offset:8192
    ds_read_b64_tr_b16 v[82:83], v125 offset:8704
    v_mfma_f32_32x32x16_bf16 v[52:67], v[88:91], v[136:139], v[52:67]
    s_waitcnt lgkmcnt(4)
    v_mfma_f32_32x32x16_bf16 v[36:51], v[68:71], v[140:143], v[36:51]
    ds_read_b64_tr_b16 v[84:85], v124 offset:10240
    ds_read_b64_tr_b16 v[86:87], v124 offset:10752
    ds_read_b64_tr_b16 v[88:89], v125 offset:10240
    ds_read_b64_tr_b16 v[90:91], v125 offset:10752
    v_mfma_f32_32x32x16_bf16 v[52:67], v[72:75], v[140:143], v[52:67]
    s_waitcnt lgkmcnt(4)
    v_mfma_f32_32x32x16_bf16 v[36:51], v[76:79], v[144:147], v[36:51]
    ds_read_b64_tr_b16 v[92:93], v126 offset:8192
    ds_read_b64_tr_b16 v[94:95], v126 offset:8704
    ds_read_b64_tr_b16 v[96:97], v127 offset:8192
    ds_read_b64_tr_b16 v[98:99], v127 offset:8704
    ds_read_b64_tr_b16 v[68:69], v124 offset:12288
    ds_read_b64_tr_b16 v[70:71], v124 offset:12800
    ds_read_b64_tr_b16 v[72:73], v125 offset:12288
    ds_read_b64_tr_b16 v[74:75], v125 offset:12800
    v_mfma_f32_32x32x16_bf16 v[52:67], v[80:83], v[144:147], v[52:67]
    s_waitcnt lgkmcnt(4)
    v_mfma_f32_32x32x16_bf16 v[36:51], v[84:87], v[148:151], v[36:51]
    ds_read_b64_tr_b16 v[76:77], v124 offset:14336
    ds_read_b64_tr_b16 v[78:79], v124 offset:14848
    ds_read_b64_tr_b16 v[80:81], v125 offset:14336
    ds_read_b64_tr_b16 v[82:83], v125 offset:14848
    v_mfma_f32_32x32x16_bf16 v[52:67], v[88:91], v[148:151], v[52:67]
    v_mfma_f32_16x16x32_bf16 v[100:103], v[108:111], v[92:95], v[100:103]
    v_mfma_f32_16x16x32_bf16 v[104:107], v[108:111], v[96:99], v[104:107]
    s_waitcnt lgkmcnt(4)
    v_mfma_f32_32x32x16_bf16 v[36:51], v[68:71], v[152:155], v[36:51]
    ds_read_b64_tr_b16 v[84:85], v124 offset:16384
    ds_read_b64_tr_b16 v[86:87], v124 offset:16896
    ds_read_b64_tr_b16 v[88:89], v125 offset:16384
    ds_read_b64_tr_b16 v[90:91], v125 offset:16896
    v_mfma_f32_32x32x16_bf16 v[52:67], v[72:75], v[152:155], v[52:67]
    s_waitcnt lgkmcnt(4)
    v_mfma_f32_32x32x16_bf16 v[36:51], v[76:79], v[156:159], v[36:51]
    ds_read_b64_tr_b16 v[68:69], v124 offset:18432
    ds_read_b64_tr_b16 v[70:71], v124 offset:18944
    ds_read_b64_tr_b16 v[72:73], v125 offset:18432
    ds_read_b64_tr_b16 v[74:75], v125 offset:18944
    v_mfma_f32_32x32x16_bf16 v[52:67], v[80:83], v[156:159], v[52:67]
    s_waitcnt lgkmcnt(4)
    v_mfma_f32_32x32x16_bf16 v[36:51], v[84:87], v[160:163], v[36:51]
    ds_read_b64_tr_b16 v[92:93], v126 offset:16384
    ds_read_b64_tr_b16 v[94:95], v126 offset:16896
    ds_read_b64_tr_b16 v[96:97], v127 offset:16384
    ds_read_b64_tr_b16 v[98:99], v127 offset:16896
    ds_read_b64_tr_b16 v[76:77], v124 offset:20480
    ds_read_b64_tr_b16 v[78:79], v124 offset:20992
    ds_read_b64_tr_b16 v[80:81], v125 offset:20480
    ds_read_b64_tr_b16 v[82:83], v125 offset:20992
    v_mfma_f32_32x32x16_bf16 v[52:67], v[88:91], v[160:163], v[52:67]
    v_and_b32 v2, 31, v1
    v_lshlrev_b32 v2, 4, v2
    v_lshrrev_b32 v3, 5, v1
    v_mul_u32_u24 v3, 3584, v3
    v_add_u32 v2, v2, v3
    buffer_load_dwordx4 v[128:131], v2, s[12:15], s87 offen offset:0 sc1
    buffer_load_dwordx4 v[132:135], v2, s[12:15], s87 offen offset:512 sc1
    buffer_load_dwordx4 v[136:139], v2, s[12:15], s87 offen offset:1024 sc1
    s_waitcnt lgkmcnt(4)
    v_mfma_f32_32x32x16_bf16 v[36:51], v[68:71], v[164:167], v[36:51]
    ds_read_b64_tr_b16 v[84:85], v124 offset:22528
    ds_read_b64_tr_b16 v[86:87], v124 offset:23040
    ds_read_b64_tr_b16 v[88:89], v125 offset:22528
    ds_read_b64_tr_b16 v[90:91], v125 offset:23040
    v_mfma_f32_32x32x16_bf16 v[52:67], v[72:75], v[164:167], v[52:67]
    v_mfma_f32_16x16x32_bf16 v[100:103], v[108:111], v[92:95], v[100:103]
    v_mfma_f32_16x16x32_bf16 v[104:107], v[108:111], v[96:99], v[104:107]
    buffer_load_dwordx4 v[140:143], v2, s[12:15], s87 offen offset:1536 sc1
    buffer_load_dwordx4 v[144:147], v2, s[12:15], s87 offen offset:2048 sc1
    s_waitcnt lgkmcnt(4)
    v_mfma_f32_32x32x16_bf16 v[36:51], v[76:79], v[168:171], v[36:51]
    ds_read_b64_tr_b16 v[68:69], v124 offset:24576
    ds_read_b64_tr_b16 v[70:71], v124 offset:25088
    ds_read_b64_tr_b16 v[72:73], v125 offset:24576
    ds_read_b64_tr_b16 v[74:75], v125 offset:25088
    v_mfma_f32_32x32x16_bf16 v[52:67], v[80:83], v[168:171], v[52:67]
    buffer_load_dwordx4 v[148:151], v2, s[12:15], s87 offen offset:2560 sc1
    buffer_load_dwordx4 v[152:155], v2, s[12:15], s87 offen offset:3072 sc1
    s_waitcnt lgkmcnt(4)
    v_mfma_f32_32x32x16_bf16 v[36:51], v[84:87], v[172:175], v[36:51]
    ds_read_b64_tr_b16 v[76:77], v124 offset:26624
    ds_read_b64_tr_b16 v[78:79], v124 offset:27136
    ds_read_b64_tr_b16 v[80:81], v125 offset:26624
    ds_read_b64_tr_b16 v[82:83], v125 offset:27136
    v_mfma_f32_32x32x16_bf16 v[52:67], v[88:91], v[172:175], v[52:67]
    s_waitcnt lgkmcnt(4)
    v_mfma_f32_32x32x16_bf16 v[36:51], v[68:71], v[176:179], v[36:51]
    ds_read_b64_tr_b16 v[92:93], v126 offset:24576
    ds_read_b64_tr_b16 v[94:95], v126 offset:25088
    ds_read_b64_tr_b16 v[96:97], v127 offset:24576
    ds_read_b64_tr_b16 v[98:99], v127 offset:25088
    ds_read_b64_tr_b16 v[84:85], v124 offset:28672
    ds_read_b64_tr_b16 v[86:87], v124 offset:29184
    ds_read_b64_tr_b16 v[88:89], v125 offset:28672
    ds_read_b64_tr_b16 v[90:91], v125 offset:29184
    v_mfma_f32_32x32x16_bf16 v[52:67], v[72:75], v[176:179], v[52:67]
    s_waitcnt lgkmcnt(4)
    v_mfma_f32_32x32x16_bf16 v[36:51], v[76:79], v[180:183], v[36:51]
    ds_read_b64_tr_b16 v[68:69], v124 offset:30720
    ds_read_b64_tr_b16 v[70:71], v124 offset:31232
    ds_read_b64_tr_b16 v[72:73], v125 offset:30720
    ds_read_b64_tr_b16 v[74:75], v125 offset:31232
    v_mfma_f32_32x32x16_bf16 v[52:67], v[80:83], v[180:183], v[52:67]
    v_mfma_f32_16x16x32_bf16 v[100:103], v[108:111], v[92:95], v[100:103]
    v_mfma_f32_16x16x32_bf16 v[104:107], v[108:111], v[96:99], v[104:107]
    s_waitcnt lgkmcnt(4)
    v_mfma_f32_32x32x16_bf16 v[36:51], v[84:87], v[184:187], v[36:51]
    v_add_u32 v124, 0xfffe8000, v124
    v_add_u32 v125, 0xfffe8000, v125
    v_add_u32 v126, 0xfffe8000, v126
    v_add_u32 v127, 0xfffe8000, v127
    ds_read_b64_tr_b16 v[76:77], v124 offset:0
    ds_read_b64_tr_b16 v[78:79], v124 offset:512
    ds_read_b64_tr_b16 v[80:81], v125 offset:0
    ds_read_b64_tr_b16 v[82:83], v125 offset:512
    v_mfma_f32_32x32x16_bf16 v[52:67], v[88:91], v[184:187], v[52:67]
    s_waitcnt lgkmcnt(4)
    v_mfma_f32_32x32x16_bf16 v[36:51], v[68:71], v[188:191], v[36:51]
    ds_read_b64_tr_b16 v[84:85], v124 offset:2048
    ds_read_b64_tr_b16 v[86:87], v124 offset:2560
    ds_read_b64_tr_b16 v[88:89], v125 offset:2048
    ds_read_b64_tr_b16 v[90:91], v125 offset:2560
    v_mfma_f32_32x32x16_bf16 v[52:67], v[72:75], v[188:191], v[52:67]
    s_waitcnt lgkmcnt(4)
    v_mfma_f32_32x32x16_bf16 v[36:51], v[76:79], v[192:195], v[36:51]
    ds_read_b64_tr_b16 v[92:93], v126 offset:0
    ds_read_b64_tr_b16 v[94:95], v126 offset:512
    ds_read_b64_tr_b16 v[96:97], v127 offset:0
    ds_read_b64_tr_b16 v[98:99], v127 offset:512
    ds_read_b64_tr_b16 v[68:69], v124 offset:4096
    ds_read_b64_tr_b16 v[70:71], v124 offset:4608
    ds_read_b64_tr_b16 v[72:73], v125 offset:4096
    ds_read_b64_tr_b16 v[74:75], v125 offset:4608
    v_mfma_f32_32x32x16_bf16 v[52:67], v[80:83], v[192:195], v[52:67]
    s_mov_b32 s34, 0
    s_mov_b32 s35, 0x3a924925
    s_waitcnt vmcnt(0)
L_pa_chk:
    v_xor_b32 v158, s11, v129
    v_xor_b32 v159, s11, v131
    v_or_b32 v158, v158, v159
    v_mov_b32 v156, v128
    v_mov_b32 v157, v130
    v_add_f32 v156, v156, v132
    v_add_f32 v157, v157, v134
    v_xor_b32 v133, s11, v133
    v_xor_b32 v135, s11, v135
    v_or3_b32 v158, v158, v133, v135
    v_add_f32 v156, v156, v136
    v_add_f32 v157, v157, v138
    v_xor_b32 v137, s11, v137
    v_xor_b32 v139, s11, v139
    v_or3_b32 v158, v158, v137, v139
    v_add_f32 v156, v156, v140
    v_add_f32 v157, v157, v142
    v_xor_b32 v141, s11, v141
    v_xor_b32 v143, s11, v143
    v_or3_b32 v158, v158, v141, v143
    v_add_f32 v156, v156, v144
    v_add_f32 v157, v157, v146
    v_xor_b32 v145, s11, v145
    v_xor_b32 v147, s11, v147
    v_or3_b32 v158, v158, v145, v147
    v_add_f32 v156, v156, v148
    v_add_f32 v157, v157, v150
    v_xor_b32 v149, s11, v149
    v_xor_b32 v151, s11, v151
    v_or3_b32 v158, v158, v149, v151
    v_add_f32 v156, v156, v152
    v_add_f32 v157, v157, v154
    v_xor_b32 v153, s11, v153
    v_xor_b32 v155, s11, v155
    v_or3_b32 v158, v158, v153, v155
    v_cmp_ne_u32 vcc, 0, v158
    s_cbranch_vccnz L_pa_retry
L_pa_chk_ok:
    v_mov_b32 v158, v156
    v_mov_b32 v159, v157
    v_and_b32 v2, 31, v1
    v_permlane32_swap_b32 v156, v158
    v_permlane32_swap_b32 v157, v159
    v_lshl_add_u32 v2, v2, 2, s52
    v_add_f32 v156, v156, v158
    v_add_f32 v157, v157, v159
    v_mul_f32 v156, s35, v156
    v_mul_f32 v158, v156, v156
    v_fma_f32 v157, v157, s35, -v158
    v_max_f32 v157, 0, v157
    v_add_f32 v157, 0x3727c5ac, v157
    v_rsq_f32 v157, v157
    v_lshrrev_b32 v3, 5, v1
    v_lshl_add_u32 v3, v3, 5, s52
    v_mul_f32_e64 v156, -v156, v157
    ds_write_b32 v2, v157 offset:1024
    ds_write_b32 v2, v156 offset:1152
    s_waitcnt lgkmcnt(0)
    ds_read_b128 v[128:131], v3 offset:1024
    ds_read_b128 v[132:135], v3 offset:1040
    ds_read_b128 v[136:139], v3 offset:1088
    ds_read_b128 v[140:143], v3 offset:1104
    ds_read_b128 v[144:147], v3 offset:1152
    ds_read_b128 v[148:151], v3 offset:1168
    ds_read_b128 v[152:155], v3 offset:1216
    ds_read_b128 v[156:159], v3 offset:1232
    v_mfma_f32_32x32x16_bf16 v[36:51], v[84:87], v[196:199], v[36:51]
    ds_read_b64_tr_b16 v[76:77], v124 offset:6144
    ds_read_b64_tr_b16 v[78:79], v124 offset:6656
    ds_read_b64_tr_b16 v[80:81], v125 offset:6144
    ds_read_b64_tr_b16 v[82:83], v125 offset:6656
    v_mfma_f32_32x32x16_bf16 v[52:67], v[88:91], v[196:199], v[52:67]
    v_mfma_f32_16x16x32_bf16 v[100:103], v[108:111], v[92:95], v[100:103]
    v_mfma_f32_16x16x32_bf16 v[104:107], v[108:111], v[96:99], v[104:107]
    s_waitcnt lgkmcnt(4)
    v_fma_f32 v4, v4, v128, v144
    v_fma_f32 v5, v5, v129, v145
    v_fma_f32 v6, v6, v130, v146
    v_fma_f32 v7, v7, v131, v147
    v_fma_f32 v8, v8, v132, v148
    v_fma_f32 v9, v9, v133, v149
    v_fma_f32 v10, v10, v134, v150
    v_fma_f32 v11, v11, v135, v151
    v_fma_f32 v12, v12, v136, v152
    v_fma_f32 v13, v13, v137, v153
    v_fma_f32 v14, v14, v138, v154
    v_fma_f32 v15, v15, v139, v155
    v_fma_f32 v16, v16, v140, v156
    v_mfma_f32_32x32x16_bf16 v[36:51], v[68:71], v[200:203], v[36:51]
    ds_read_b64_tr_b16 v[84:85], v124 offset:8192
    ds_read_b64_tr_b16 v[86:87], v124 offset:8704
    ds_read_b64_tr_b16 v[88:89], v125 offset:8192
    ds_read_b64_tr_b16 v[90:91], v125 offset:8704
    v_mfma_f32_32x32x16_bf16 v[52:67], v[72:75], v[200:203], v[52:67]
    v_fma_f32 v17, v17, v141, v157
    v_fma_f32 v18, v18, v142, v158
    v_fma_f32 v19, v19, v143, v159
    v_cvt_pk_bf16_f32 v4, v4, v5
    v_cvt_pk_bf16_f32 v5, v6, v7
    v_cvt_pk_bf16_f32 v6, v8, v9
    v_cvt_pk_bf16_f32 v7, v10, v11
    v_cvt_pk_bf16_f32 v8, v12, v13
    v_cvt_pk_bf16_f32 v9, v14, v15
    v_cvt_pk_bf16_f32 v10, v16, v17
    v_cvt_pk_bf16_f32 v11, v18, v19
    buffer_store_dwordx4 v[4:7], v120, s[12:15], s83 offen offset:0 sc1
    buffer_store_dwordx4 v[8:11], v120, s[12:15], s84 offen offset:0 sc1
    v_fma_f32 v20, v20, v128, v144
    s_waitcnt lgkmcnt(4)
    v_mfma_f32_32x32x16_bf16 v[36:51], v[76:79], v[204:207], v[36:51]
    ds_read_b64_tr_b16 v[68:69], v124 offset:10240
    ds_read_b64_tr_b16 v[70:71], v124 offset:10752
    ds_read_b64_tr_b16 v[72:73], v125 offset:10240
    ds_read_b64_tr_b16 v[74:75], v125 offset:10752
    v_mfma_f32_32x32x16_bf16 v[52:67], v[80:83], v[204:207], v[52:67]
    v_fma_f32 v21, v21, v129, v145
    v_fma_f32 v22, v22, v130, v146
    v_fma_f32 v23, v23, v131, v147
    v_fma_f32 v24, v24, v132, v148
    v_fma_f32 v25, v25, v133, v149
    v_fma_f32 v26, v26, v134, v150
    v_fma_f32 v27, v27, v135, v151
    v_fma_f32 v28, v28, v136, v152
    v_fma_f32 v29, v29, v137, v153
    v_fma_f32 v30, v30, v138, v154
    v_fma_f32 v31, v31, v139, v155
    v_fma_f32 v32, v32, v140, v156
    v_fma_f32 v33, v33, v141, v157
    v_fma_f32 v34, v34, v142, v158
    s_waitcnt lgkmcnt(4)
    v_mfma_f32_32x32x16_bf16 v[36:51], v[84:87], v[208:211], v[36:51]
    ds_read_b64_tr_b16 v[92:93], v126 offset:8192
    ds_read_b64_tr_b16 v[94:95], v126 offset:8704
    ds_read_b64_tr_b16 v[96:97], v127 offset:8192
    ds_read_b64_tr_b16 v[98:99], v127 offset:8704
    ds_read_b64_tr_b16 v[76:77], v124 offset:12288
    ds_read_b64_tr_b16 v[78:79], v124 offset:12800
    ds_read_b64_tr_b16 v[80:81], v125 offset:12288
    ds_read_b64_tr_b16 v[82:83], v125 offset:12800
    v_mfma_f32_32x32x16_bf16 v[52:67], v[88:91], v[208:211], v[52:67]
    v_fma_f32 v35, v35, v143, v159
    v_cvt_pk_bf16_f32 v20, v20, v21
    v_cvt_pk_bf16_f32 v21, v22, v23
    v_cvt_pk_bf16_f32 v22, v24, v25
    v_cvt_pk_bf16_f32 v23, v26, v27
    v_cvt_pk_bf16_f32 v24, v28, v29
    v_cvt_pk_bf16_f32 v25, v30, v31
    v_cvt_pk_bf16_f32 v26, v32, v33
    v_cvt_pk_bf16_f32 v27, v34, v35
    buffer_store_dwordx4 v[20:23], v120, s[12:15], s83 offen offset:1024 sc1
    buffer_store_dwordx4 v[24:27], v120, s[12:15], s84 offen offset:1024 sc1
    s_waitcnt lgkmcnt(4)
    v_mfma_f32_32x32x16_bf16 v[36:51], v[68:71], v[212:215], v[36:51]
    ds_read_b64_tr_b16 v[84:85], v124 offset:14336
    ds_read_b64_tr_b16 v[86:87], v124 offset:14848
    ds_read_b64_tr_b16 v[88:89], v125 offset:14336
    ds_read_b64_tr_b16 v[90:91], v125 offset:14848
    v_mfma_f32_32x32x16_bf16 v[52:67], v[72:75], v[212:215], v[52:67]
    v_mfma_f32_16x16x32_bf16 v[100:103], v[108:111], v[92:95], v[100:103]
    v_mfma_f32_16x16x32_bf16 v[104:107], v[108:111], v[96:99], v[104:107]
    s_waitcnt lgkmcnt(4)
    v_mfma_f32_32x32x16_bf16 v[36:51], v[76:79], v[216:219], v[36:51]
    ds_read_b64_tr_b16 v[68:69], v124 offset:16384
    ds_read_b64_tr_b16 v[70:71], v124 offset:16896
    ds_read_b64_tr_b16 v[72:73], v125 offset:16384
    ds_read_b64_tr_b16 v[74:75], v125 offset:16896
    v_mfma_f32_32x32x16_bf16 v[52:67], v[80:83], v[216:219], v[52:67]
    s_waitcnt lgkmcnt(4)
    v_mfma_f32_32x32x16_bf16 v[36:51], v[84:87], v[220:223], v[36:51]
    ds_read_b64_tr_b16 v[76:77], v124 offset:18432
    ds_read_b64_tr_b16 v[78:79], v124 offset:18944
    ds_read_b64_tr_b16 v[80:81], v125 offset:18432
    ds_read_b64_tr_b16 v[82:83], v125 offset:18944
    v_mfma_f32_32x32x16_bf16 v[52:67], v[88:91], v[220:223], v[52:67]
    s_waitcnt lgkmcnt(4)
    v_mfma_f32_32x32x16_bf16 v[36:51], v[68:71], v[224:227], v[36:51]
    ds_read_b64_tr_b16 v[92:93], v126 offset:16384
    ds_read_b64_tr_b16 v[94:95], v126 offset:16896
    ds_read_b64_tr_b16 v[96:97], v127 offset:16384
    ds_read_b64_tr_b16 v[98:99], v127 offset:16896
    ds_read_b64_tr_b16 v[84:85], v124 offset:20480
    ds_read_b64_tr_b16 v[86:87], v124 offset:20992
    ds_read_b64_tr_b16 v[88:89], v125 offset:20480
    ds_read_b64_tr_b16 v[90:91], v125 offset:20992
    v_mfma_f32_32x32x16_bf16 v[52:67], v[72:75], v[224:227], v[52:67]
    s_waitcnt lgkmcnt(4)
    v_mfma_f32_32x32x16_bf16 v[36:51], v[76:79], v[228:231], v[36:51]
    ds_read_b64_tr_b16 v[68:69], v124 offset:22528
    ds_read_b64_tr_b16 v[70:71], v124 offset:23040
    ds_read_b64_tr_b16 v[72:73], v125 offset:22528
    ds_read_b64_tr_b16 v[74:75], v125 offset:23040
    v_mfma_f32_32x32x16_bf16 v[52:67], v[80:83], v[228:231], v[52:67]
    v_mfma_f32_16x16x32_bf16 v[100:103], v[108:111], v[92:95], v[100:103]
    v_mfma_f32_16x16x32_bf16 v[104:107], v[108:111], v[96:99], v[104:107]
    s_waitcnt lgkmcnt(4)
    v_mfma_f32_32x32x16_bf16 v[36:51], v[84:87], v[232:235], v[36:51]
    ds_read_b64_tr_b16 v[76:77], v124 offset:24576
    ds_read_b64_tr_b16 v[78:79], v124 offset:25088
    ds_read_b64_tr_b16 v[80:81], v125 offset:24576
    ds_read_b64_tr_b16 v[82:83], v125 offset:25088
    v_mfma_f32_32x32x16_bf16 v[52:67], v[88:91], v[232:235], v[52:67]
    s_waitcnt lgkmcnt(4)
    v_mfma_f32_32x32x16_bf16 v[36:51], v[68:71], v[236:239], v[36:51]
    ds_read_b64_tr_b16 v[84:85], v124 offset:26624
    ds_read_b64_tr_b16 v[86:87], v124 offset:27136
    ds_read_b64_tr_b16 v[88:89], v125 offset:26624
    ds_read_b64_tr_b16 v[90:91], v125 offset:27136
    v_mfma_f32_32x32x16_bf16 v[52:67], v[72:75], v[236:239], v[52:67]
    s_waitcnt lgkmcnt(4)
    v_mfma_f32_32x32x16_bf16 v[36:51], v[76:79], v[240:243], v[36:51]
    ds_read_b64_tr_b16 v[92:93], v126 offset:24576
    ds_read_b64_tr_b16 v[94:95], v126 offset:25088
    ds_read_b64_tr_b16 v[96:97], v127 offset:24576
    ds_read_b64_tr_b16 v[98:99], v127 offset:25088
    ds_read_b64_tr_b16 v[68:69], v124 offset:28672
    ds_read_b64_tr_b16 v[70:71], v124 offset:29184
    ds_read_b64_tr_b16 v[72:73], v125 offset:28672
    ds_read_b64_tr_b16 v[74:75], v125 offset:29184
    v_mfma_f32_32x32x16_bf16 v[52:67], v[80:83], v[240:243], v[52:67]
    v_mov_b32 v2, s11
    s_waitcnt vmcnt(0)
    buffer_store_dword v2, off, s[12:15], s86 sc1
    s_waitcnt lgkmcnt(4)
    v_mfma_f32_32x32x16_bf16 v[36:51], v[84:87], v[244:247], v[36:51]
    ds_read_b64_tr_b16 v[76:77], v124 offset:30720
    ds_read_b64_tr_b16 v[78:79], v124 offset:31232
    ds_read_b64_tr_b16 v[80:81], v125 offset:30720
    ds_read_b64_tr_b16 v[82:83], v125 offset:31232
    v_mfma_f32_32x32x16_bf16 v[52:67], v[88:91], v[244:247], v[52:67]
    v_mfma_f32_16x16x32_bf16 v[100:103], v[108:111], v[92:95], v[100:103]
    v_mfma_f32_16x16x32_bf16 v[104:107], v[108:111], v[96:99], v[104:107]
    s_waitcnt lgkmcnt(4)
    v_mfma_f32_32x32x16_bf16 v[36:51], v[68:71], v[248:251], v[36:51]
    v_mfma_f32_32x32x16_bf16 v[52:67], v[72:75], v[248:251], v[52:67]
    v_lshl_add_u32 v3, v1, 2, s52
    s_nop 2
    ds_write_b32 v3, v100 offset:0
    ds_write_b32 v3, v104 offset:256
    s_waitcnt lgkmcnt(2)
    v_mfma_f32_32x32x16_bf16 v[36:51], v[76:79], v[252:255], v[36:51]
    v_mfma_f32_32x32x16_bf16 v[52:67], v[80:83], v[252:255], v[52:67]
    v_mov_b32 v2, 1
    s_waitcnt lgkmcnt(0)
    ds_write_b32 v123, v2 offset:128
    s_setprio 2
    v_mov_b32 v2, 0
L_pa_csz:
    ds_read_b128 v[96:99], v2 offset:128
    s_waitcnt lgkmcnt(0)
    v_min_u32 v96, v96, v97
    v_min3_u32 v96, v96, v98, v99
    v_cmp_gt_u32 vcc, 1, v96
    s_cbranch_vccz L_pa_csz_ok
    s_sleep 0
    s_branch L_pa_csz
L_pa_csz_ok:
    v_lshlrev_b32 v2, 2, v1
    v_add_u32 v2, 65536, v2
    ds_read_b32 v68, v2 offset:0
    ds_read_b32 v69, v2 offset:2048
    ds_read_b32 v70, v2 offset:4096
    ds_read_b32 v71, v2 offset:6144
    ds_read_b32 v72, v2 offset:256
    ds_read_b32 v73, v2 offset:2304
    ds_read_b32 v74, v2 offset:4352
    ds_read_b32 v75, v2 offset:6400
    v_mov_b32 v94, 0
    v_mov_b32 v95, 0
    s_waitcnt lgkmcnt(0)
    v_add_f32 v68, v68, v69
    v_add_f32 v70, v70, v71
    v_add_f32 v68, v68, v70
    v_sub_f32 v68, 0, v68
    v_cvt_pk_bf16_f32 v93, v68, 0
    v_lshlrev_b32 v69, 16, v93
    v_sub_f32 v69, v68, v69
    v_cvt_pk_bf16_f32 v92, v68, v69
    s_nop 1
    v_mfma_f32_32x32x16_bf16 v[36:51], v[92:95], v[112:115], v[36:51]
    v_add_f32 v72, v72, v73
    v_add_f32 v74, v74, v75
    v_add_f32 v72, v72, v74
    v_sub_f32 v72, 0, v72
    v_cvt_pk_bf16_f32 v93, v72, 0
    v_lshlrev_b32 v73, 16, v93
    v_sub_f32 v73, v72, v73
    v_cvt_pk_bf16_f32 v92, v72, v73
    s_nop 1
    v_mfma_f32_32x32x16_bf16 v[52:67], v[92:95], v[112:115], v[52:67]
    s_nop 0
    v_mul_f32 v68, v36, v36
    v_mul_f32 v69, v37, v37
    v_mul_f32 v70, v38, v38
    v_mul_f32 v71, v39, v39
    v_fma_f32 v68, v68, v119, v118
    v_fma_f32 v69, v69, v119, v118
    v_fma_f32 v70, v70, v119, v118
    v_fma_f32 v71, v71, v119, v118
    v_mul_f32 v68, v68, v36
    v_mul_f32 v69, v69, v37
    v_mul_f32 v70, v70, v38
    v_mul_f32 v71, v71, v39
    v_exp_f32 v68, v68
    v_exp_f32 v69, v69
    v_exp_f32 v70, v70
    v_exp_f32 v71, v71
    v_fma_f32 v68, v68, v117, v117
    v_fma_f32 v69, v69, v117, v117
    v_fma_f32 v70, v70, v117, v117
    v_fma_f32 v71, v71, v117, v117
    v_rcp_f32 v68, v68
    v_rcp_f32 v69, v69
    v_rcp_f32 v70, v70
    v_rcp_f32 v71, v71
    v_mul_f32 v36, v36, v68
    v_mul_f32 v37, v37, v69
    v_mul_f32 v38, v38, v70
    v_mul_f32 v39, v39, v71
    v_cvt_pk_bf16_f32 v72, v36, v37
    v_cvt_pk_bf16_f32 v73, v38, v39
    v_mul_f32 v68, v40, v40
    v_mul_f32 v69, v41, v41
    v_mul_f32 v70, v42, v42
    v_mul_f32 v71, v43, v43
    v_fma_f32 v68, v68, v119, v118
    v_fma_f32 v69, v69, v119, v118
    v_fma_f32 v70, v70, v119, v118
    v_fma_f32 v71, v71, v119, v118
    v_mul_f32 v68, v68, v40
    v_mul_f32 v69, v69, v41
    v_mul_f32 v70, v70, v42
    v_mul_f32 v71, v71, v43
    v_exp_f32 v68, v68
    v_exp_f32 v69, v69
    v_exp_f32 v70, v70
    v_exp_f32 v71, v71
    v_fma_f32 v68, v68, v117, v117
    v_fma_f32 v69, v69, v117, v117
    v_fma_f32 v70, v70, v117, v117
    v_fma_f32 v71, v71, v117, v117
    v_rcp_f32 v68, v68
    v_rcp_f32 v69, v69
    v_rcp_f32 v70, v70
    v_rcp_f32 v71, v71
    v_mul_f32 v40, v40, v68
    v_mul_f32 v41, v41, v69
    v_mul_f32 v42, v42, v70
    v_mul_f32 v43, v43, v71
    v_cvt_pk_bf16_f32 v74, v40, v41
    v_cvt_pk_bf16_f32 v75, v42, v43
    v_mul_f32 v68, v44, v44
    v_mul_f32 v69, v45, v45
    v_mul_f32 v70, v46, v46
    v_mul_f32 v71, v47, v47
    v_fma_f32 v68, v68, v119, v118
    v_fma_f32 v69, v69, v119, v118
    v_fma_f32 v70, v70, v119, v118
    v_fma_f32 v71, v71, v119, v118
    v_mul_f32 v68, v68, v44
    v_mul_f32 v69, v69, v45
    v_mul_f32 v70, v70, v46
    v_mul_f32 v71, v71, v47
    v_exp_f32 v68, v68
    v_exp_f32 v69, v69
    v_exp_f32 v70, v70
    v_exp_f32 v71, v71
    v_fma_f32 v68, v68, v117, v117
    v_fma_f32 v69, v69, v117, v117
    v_fma_f32 v70, v70, v117, v117
    v_fma_f32 v71, v71, v117, v117
    v_rcp_f32 v68, v68
    v_rcp_f32 v69, v69
    v_rcp_f32 v70, v70
    v_rcp_f32 v71, v71
    v_mul_f32 v44, v44, v68
    v_mul_f32 v45, v45, v69
    v_mul_f32 v46, v46, v70
    v_mul_f32 v47, v47, v71
    v_cvt_pk_bf16_f32 v76, v44, v45
    v_cvt_pk_bf16_f32 v77, v46, v47
    v_mul_f32 v68, v48, v48
    v_mul_f32 v69, v49, v49
    v_mul_f32 v70, v50, v50
    v_mul_f32 v71, v51, v51
    v_fma_f32 v68, v68, v119, v118
    v_fma_f32 v69, v69, v119, v118
    v_fma_f32 v70, v70, v119, v118
    v_fma_f32 v71, v71, v119, v118
    v_mul_f32 v68, v68, v48
    v_mul_f32 v69, v69, v49
    v_mul_f32 v70, v70, v50
    v_mul_f32 v71, v71, v51
    v_exp_f32 v68, v68
    v_exp_f32 v69, v69
    v_exp_f32 v70, v70
    v_exp_f32 v71, v71
    v_fma_f32 v68, v68, v117, v117
    v_fma_f32 v69, v69, v117, v117
    v_fma_f32 v70, v70, v117, v117
    v_fma_f32 v71, v71, v117, v117
    v_rcp_f32 v68, v68
    v_rcp_f32 v69, v69
    v_rcp_f32 v70, v70
    v_rcp_f32 v71, v71
    v_mul_f32 v48, v48, v68
    v_mul_f32 v49, v49, v69
    v_mul_f32 v50, v50, v70
    v_mul_f32 v51, v51, v71
    v_cvt_pk_bf16_f32 v78, v48, v49
    v_cvt_pk_bf16_f32 v79, v50, v51
    buffer_store_dwordx4 v[72:75], v120, s[12:15], s85 offen offset:0 sc1
    buffer_store_dwordx4 v[76:79], v120, s[12:15], s85 offen offset:1024 sc1
    s_add_u32 s89, s86, 16
L_pa_b_done:
    s_mov_b32 s24, s10
    s_and_b32 s25, s2, 7
    s_lshr_b32 s26, s2, 3
    s_lshr_b32 s27, s26, 3
    s_lshl_b32 s28, s25, 2
    s_add_u32 s27, s27, s28
    s_and_b32 s28, s26, 7
    s_load_dwordx4 s[4:7], s[0:1], 40
    s_sub_u32 s24, s24, 4
    v_lshlrev_b32 v244, 4, v1
    s_mul_i32 s63, s27, 131072
    s_lshl_b32 s62, s24, 11
    s_add_u32 s63, s63, s62
    s_add_u32 s63, s63, 2097152
    s_mul_i32 s62, s24, 2080
    s_lshl_b32 s46, s24, 2
    s_add_u32 s46, s46, 0
    v_mov_b32 v251, s46
    v_mov_b32 v0, 1
    v_mov_b32 v2, 0
    s_waitcnt lgkmcnt(0)
    ds_write_b32 v251, v0 offset:160
    s_mov_b32 s16, s4
    s_mov_b32 s17, s5
    s_mov_b32 s18, 0x800000
    s_mov_b32 s19, 0x20000
    s_mov_b32 s20, s6
    s_mov_b32 s21, s7
    s_mov_b32 s22, 0x1000
    s_mov_b32 s23, 0x20000
L_pa_g_bd:
    ds_read_b128 v[4:7], v2 offset:160
    s_waitcnt lgkmcnt(0)
    v_min_u32 v4, v4, v5
    v_min3_u32 v4, v4, v6, v7
    v_cmp_gt_u32 vcc, 1, v4
    s_cbranch_vccz L_pa_g_bd_ok
    s_sleep 1
    s_branch L_pa_g_bd
L_pa_g_bd_ok:
L_pa_g_go:
    ds_read_b128 v[4:7], v2 offset:176
    s_waitcnt lgkmcnt(0)
    v_min_u32 v4, v4, v5
    v_min3_u32 v4, v4, v6, v7
    v_cmp_gt_u32 vcc, 1, v4
    s_cbranch_vccz L_pa_g_go_ok
    s_sleep 2
    s_branch L_pa_g_go
L_pa_g_go_ok:
    v_mul_u32_u24 v16, 2080, v1
    v_mov_b32 v8, 0x3f803f80
    v_mov_b32 v12, 0
    v_mov_b32 v9, 0x3f803f80
    v_mov_b32 v13, 0
    v_mov_b32 v10, 0x3f803f80
    v_mov_b32 v14, 0
    v_mov_b32 v11, 0x3f803f80
    v_mov_b32 v15, 0
    s_mov_b32 exec_lo, 0xfffff000
    s_mov_b32 exec_hi, 0x3fffffff
    ds_write_b128 v16, v[8:11] offset:4128
    ds_write_b128 v16, v[12:15] offset:4144
    s_mov_b64 exec, -1
    s_add_u32 m0, s62, 27040
    s_add_u32 s61, s63, 28672
    buffer_load_dwordx4 v244, s[12:15], s61 offen offset:0 sc1 lds
    buffer_load_dwordx4 v244, s[12:15], s61 offen offset:1024 sc1 lds
    s_add_u32 m0, s62, 35360
    s_add_u32 s61, s63, 36864
    buffer_load_dwordx4 v244, s[12:15], s61 offen offset:0 sc1 lds
    buffer_load_dwordx4 v244, s[12:15], s61 offen offset:1024 sc1 lds
    s_add_u32 m0, s62, 43680
    s_add_u32 s61, s63, 45056
    buffer_load_dwordx4 v244, s[12:15], s61 offen offset:0 sc1 lds
    buffer_load_dwordx4 v244, s[12:15], s61 offen offset:1024 sc1 lds
    s_add_u32 m0, s62, 52000
    s_add_u32 s61, s63, 53248
    buffer_load_dwordx4 v244, s[12:15], s61 offen offset:0 sc1 lds
    buffer_load_dwordx4 v244, s[12:15], s61 offen offset:1024 sc1 lds
    s_add_u32 m0, s62, 60320
    s_add_u32 s61, s63, 61440
    buffer_load_dwordx4 v244, s[12:15], s61 offen offset:0 sc1 lds
    buffer_load_dwordx4 v244, s[12:15], s61 offen offset:1024 sc1 lds
    s_add_u32 m0, s62, 68640
    s_add_u32 s61, s63, 69632
    buffer_load_dwordx4 v244, s[12:15], s61 offen offset:0 sc1 lds
    buffer_load_dwordx4 v244, s[12:15], s61 offen offset:1024 sc1 lds
    s_add_u32 m0, s62, 76960
    s_add_u32 s61, s63, 77824
    buffer_load_dwordx4 v244, s[12:15], s61 offen offset:0 sc1 lds
    buffer_load_dwordx4 v244, s[12:15], s61 offen offset:1024 sc1 lds
    s_add_u32 m0, s62, 85280
    s_add_u32 s61, s63, 86016
    buffer_load_dwordx4 v244, s[12:15], s61 offen offset:0 sc1 lds
    buffer_load_dwordx4 v244, s[12:15], s61 offen offset:1024 sc1 lds
    s_add_u32 m0, s62, 93600
    s_add_u32 s61, s63, 94208
    buffer_load_dwordx4 v244, s[12:15], s61 offen offset:0 sc1 lds
    buffer_load_dwordx4 v244, s[12:15], s61 offen offset:1024 sc1 lds
    s_add_u32 m0, s62, 101920
    s_add_u32 s61, s63, 102400
    buffer_load_dwordx4 v244, s[12:15], s61 offen offset:0 sc1 lds
    buffer_load_dwordx4 v244, s[12:15], s61 offen offset:1024 sc1 lds
    s_add_u32 m0, s62, 110240
    s_add_u32 s61, s63, 110592
    buffer_load_dwordx4 v244, s[12:15], s61 offen offset:0 sc1 lds
    buffer_load_dwordx4 v244, s[12:15], s61 offen offset:1024 sc1 lds
    s_add_u32 m0, s62, 118560
    s_add_u32 s61, s63, 118784
    buffer_load_dwordx4 v244, s[12:15], s61 offen offset:0 sc1 lds
    buffer_load_dwordx4 v244, s[12:15], s61 offen offset:1024 sc1 lds
    s_add_u32 s62, s62, 126880
    s_add_u32 s61, s63, 126976
    s_cmp_ge_u32 s24, 2
    s_cselect_b32 m0, 0x30000, s62
    s_nop 0
    buffer_load_dwordx4 v244, s[12:15], s61 offen offset:0 sc1 lds
    buffer_load_dwordx4 v244, s[12:15], s61 offen offset:1024 sc1 lds
    s_cmp_ge_u32 s26, 28
    s_cbranch_scc1 L_pa_idle
    s_setprio 3
    s_mul_i32 s30, s26, 9363
    s_lshr_b32 s30, s30, 16
    s_mul_i32 s31, s30, 7
    s_sub_u32 s31, s26, s31
    s_lshl_b32 s32, s25, 2
    s_add_u32 s30, s30, s32
    s_lshl_b32 s33, s31, 19
    s_add_u32 s33, s33, 10485760
    s_lshl_b32 s34, s24, 17
    s_add_u32 s33, s33, s34
    s_lshl_b32 s56, s30, 18
    s_lshl_b32 s34, s24, 10
    s_add_u32 s56, s56, s34
    s_lshl_b32 s36, s24, 13
    s_add_u32 s36, s36, 131072
    s_add_u32 s37, s36, 4096
    v_lshrrev_b32 v2, 3, v1
    v_lshrrev_b32 v3, 4, v1
    v_xor_b32 v3, v3, v1
    v_and_b32 v3, 7, v3
    v_lshlrev_b32 v3, 4, v3
    v_lshl_add_u32 v245, v2, 12, v3
    v_xor_b32 v246, 64, v245
    v_add_u32 v246, 31744, v246
    s_add_u32 s38, s24, 0
    s_and_b32 s38, s38, 3
    s_lshl_b32 s38, s38, 10
    s_add_u32 s52, s33, s38
    s_add_u32 s38, s24, 1
    s_and_b32 s38, s38, 3
    s_lshl_b32 s38, s38, 10
    s_add_u32 s53, s33, s38
    s_add_u32 s38, s24, 2
    s_and_b32 s38, s38, 3
    s_lshl_b32 s38, s38, 10
    s_add_u32 s54, s33, s38
    s_add_u32 s38, s24, 3
    s_and_b32 s38, s38, 3
    s_lshl_b32 s38, s38, 10
    s_add_u32 s55, s33, s38
    s_lshl_b32 s38, s31, 12
    s_lshl_b32 s39, s24, 9
    s_add_u32 s39, s39, s38
    s_add_u32 s39, s39, 28344336
    s_lshr_b32 s49, s24, 1
    s_lshl_b32 s49, s49, 11
    s_add_u32 s49, s49, s38
    s_lshr_b32 s38, s30, 1
    s_lshl_b32 s38, s38, 7
    s_add_u32 s49, s49, s38
    s_and_b32 s38, s30, 1
    s_lshl_b32 s38, s38, 3
    s_add_u32 s49, s49, s38
    s_add_u32 s49, s49, 28704
    v_and_b32 v4, 3, v1
    v_bfe_u32 v5, v1, 2, 1
    v_lshlrev_b32 v5, 11, v5
    v_lshl_add_u32 v4, v4, 7, v5
    v_bfe_u32 v5, v1, 3, 2
    v_lshl_add_u32 v4, v5, 2, v4
    s_mov_b32 m0, s36
    s_add_u32 s57, s56, 0
    buffer_load_dwordx4 v245, s[16:19], s57 offen offset:0 sc1 lds
    buffer_load_dwordx4 v246, s[16:19], s57 offen offset:1024 sc1 lds
    s_add_u32 s57, s56, 63488
    buffer_load_dwordx4 v245, s[16:19], s57 offen offset:2048 sc1 lds
    buffer_load_dwordx4 v246, s[16:19], s57 offen offset:3072 sc1 lds
    s_mov_b32 m0, s37
    s_add_u32 s57, s56, 131072
    buffer_load_dwordx4 v245, s[16:19], s57 offen offset:0 sc1 lds
    buffer_load_dwordx4 v246, s[16:19], s57 offen offset:1024 sc1 lds
    s_add_u32 s57, s56, 194560
    buffer_load_dwordx4 v245, s[16:19], s57 offen offset:2048 sc1 lds
    buffer_load_dwordx4 v246, s[16:19], s57 offen offset:3072 sc1 lds
    s_add_u32 s56, s56, 128
    s_cmp_ge_u32 s88, 14
    s_cbranch_scc1 L_pa_b_mida
    v_mul_f32 v68, v52, v52
    v_mul_f32 v69, v53, v53
    v_mul_f32 v70, v54, v54
    v_mul_f32 v71, v55, v55
    v_fma_f32 v68, v68, v119, v118
    v_fma_f32 v69, v69, v119, v118
    v_fma_f32 v70, v70, v119, v118
    v_fma_f32 v71, v71, v119, v118
    v_mul_f32 v68, v68, v52
    v_mul_f32 v69, v69, v53
    v_mul_f32 v70, v70, v54
    v_mul_f32 v71, v71, v55
    v_exp_f32 v68, v68
    v_exp_f32 v69, v69
    v_exp_f32 v70, v70
    v_exp_f32 v71, v71
    v_fma_f32 v68, v68, v117, v117
    v_fma_f32 v69, v69, v117, v117
    v_fma_f32 v70, v70, v117, v117
    v_fma_f32 v71, v71, v117, v117
    v_rcp_f32 v68, v68
    v_rcp_f32 v69, v69
    v_rcp_f32 v70, v70
    v_rcp_f32 v71, v71
    v_mul_f32 v52, v52, v68
    v_mul_f32 v53, v53, v69
    v_mul_f32 v54, v54, v70
    v_mul_f32 v55, v55, v71
    v_cvt_pk_bf16_f32 v80, v52, v53
    v_cvt_pk_bf16_f32 v81, v54, v55
    v_mul_f32 v68, v56, v56
    v_mul_f32 v69, v57, v57
    v_mul_f32 v70, v58, v58
    v_mul_f32 v71, v59, v59
    v_fma_f32 v68, v68, v119, v118
    v_fma_f32 v69, v69, v119, v118
    v_fma_f32 v70, v70, v119, v118
    v_fma_f32 v71, v71, v119, v118
    v_mul_f32 v68, v68, v56
    v_mul_f32 v69, v69, v57
    v_mul_f32 v70, v70, v58
    v_mul_f32 v71, v71, v59
    v_exp_f32 v68, v68
    v_exp_f32 v69, v69
    v_exp_f32 v70, v70
    v_exp_f32 v71, v71
    v_fma_f32 v68, v68, v117, v117
    v_fma_f32 v69, v69, v117, v117
    v_fma_f32 v70, v70, v117, v117
    v_fma_f32 v71, v71, v117, v117
    v_rcp_f32 v68, v68
    v_rcp_f32 v69, v69
    v_rcp_f32 v70, v70
    v_rcp_f32 v71, v71
    v_mul_f32 v56, v56, v68
    v_mul_f32 v57, v57, v69
    v_mul_f32 v58, v58, v70
    v_mul_f32 v59, v59, v71
    v_cvt_pk_bf16_f32 v82, v56, v57
    v_cvt_pk_bf16_f32 v83, v58, v59
    s_waitcnt vmcnt(8) lgkmcnt(0)
    ds_write_b32 v251, v0 offset:48
    v_mul_f32 v68, v60, v60
    v_mul_f32 v69, v61, v61
    v_mul_f32 v70, v62, v62
    v_mul_f32 v71, v63, v63
    v_fma_f32 v68, v68, v119, v118
    v_fma_f32 v69, v69, v119, v118
    v_fma_f32 v70, v70, v119, v118
    v_fma_f32 v71, v71, v119, v118
    v_mul_f32 v68, v68, v60
    v_mul_f32 v69, v69, v61
    v_mul_f32 v70, v70, v62
    v_mul_f32 v71, v71, v63
    v_exp_f32 v68, v68
    v_exp_f32 v69, v69
    v_exp_f32 v70, v70
    v_exp_f32 v71, v71
    v_fma_f32 v68, v68, v117, v117
    v_fma_f32 v69, v69, v117, v117
    v_fma_f32 v70, v70, v117, v117
    v_fma_f32 v71, v71, v117, v117
    v_rcp_f32 v68, v68
    v_rcp_f32 v69, v69
    v_rcp_f32 v70, v70
    v_rcp_f32 v71, v71
    v_mul_f32 v60, v60, v68
    v_mul_f32 v61, v61, v69
    v_mul_f32 v62, v62, v70
    v_mul_f32 v63, v63, v71
    v_cvt_pk_bf16_f32 v84, v60, v61
    v_cvt_pk_bf16_f32 v85, v62, v63
    v_mul_f32 v68, v64, v64
    v_mul_f32 v69, v65, v65
    v_mul_f32 v70, v66, v66
    v_mul_f32 v71, v67, v67
    v_fma_f32 v68, v68, v119, v118
    v_fma_f32 v69, v69, v119, v118
    v_fma_f32 v70, v70, v119, v118
    v_fma_f32 v71, v71, v119, v118
    v_mul_f32 v68, v68, v64
    v_mul_f32 v69, v69, v65
    v_mul_f32 v70, v70, v66
    v_mul_f32 v71, v71, v67
    v_exp_f32 v68, v68
    v_exp_f32 v69, v69
    v_exp_f32 v70, v70
    v_exp_f32 v71, v71
    v_fma_f32 v68, v68, v117, v117
    v_fma_f32 v69, v69, v117, v117
    v_fma_f32 v70, v70, v117, v117
    v_fma_f32 v71, v71, v117, v117
    v_rcp_f32 v68, v68
    v_rcp_f32 v69, v69
    v_rcp_f32 v70, v70
    v_rcp_f32 v71, v71
    v_mul_f32 v64, v64, v68
    v_mul_f32 v65, v65, v69
    v_mul_f32 v66, v66, v70
    v_mul_f32 v67, v67, v71
    v_cvt_pk_bf16_f32 v86, v64, v65
    v_cvt_pk_bf16_f32 v87, v66, v67
    buffer_store_dwordx4 v[80:83], v120, s[12:15], s85 offen offset:2048 sc1
    buffer_store_dwordx4 v[84:87], v120, s[12:15], s85 offen offset:3072 sc1
L_pa_b_mida:
    s_waitcnt vmcnt(8) lgkmcnt(0)
    ds_write_b32 v251, v0 offset:48
    s_mov_b32 s47, 0
L_pa_pz:
    buffer_load_dword v5, v4, s[12:15], s39 offen sc1
    s_add_u32 s47, s47, 1
    s_waitcnt vmcnt(0)
    v_cmp_ne_u32 vcc, s11, v5
    s_cbranch_vccz L_pa_pz_ok
    s_cmp_gt_u32 s47, 0x10000
    s_cbranch_scc1 L_pa_pz_ok
    s_sleep 4
    s_branch L_pa_pz
L_pa_pz_ok:
    v_mov_b32 v0, s11
    buffer_store_dword v0, off, s[12:15], s89 sc1
    buffer_load_dwordx4 v[132:135], v244, s[12:15], s52 offen sc1
    s_add_u32 s52, s52, 4096
    buffer_load_dwordx4 v[136:139], v244, s[12:15], s53 offen sc1
    s_add_u32 s53, s53, 4096
    buffer_load_dwordx4 v[140:143], v244, s[12:15], s54 offen sc1
    s_add_u32 s54, s54, 4096
    buffer_load_dwordx4 v[144:147], v244, s[12:15], s55 offen sc1
    s_add_u32 s55, s55, 4096
    buffer_load_dwordx4 v[148:151], v244, s[12:15], s52 offen sc1
    s_add_u32 s52, s52, 4096
    buffer_load_dwordx4 v[152:155], v244, s[12:15], s53 offen sc1
    s_add_u32 s53, s53, 4096
    buffer_load_dwordx4 v[156:159], v244, s[12:15], s54 offen sc1
    s_add_u32 s54, s54, 4096
    buffer_load_dwordx4 v[160:163], v244, s[12:15], s55 offen sc1
    s_add_u32 s55, s55, 4096
    buffer_load_dwordx4 v[164:167], v244, s[12:15], s52 offen sc1
    s_add_u32 s52, s52, 4096
    buffer_load_dwordx4 v[168:171], v244, s[12:15], s53 offen sc1
    s_add_u32 s53, s53, 4096
    buffer_load_dwordx4 v[172:175], v244, s[12:15], s54 offen sc1
    s_add_u32 s54, s54, 4096
    buffer_load_dwordx4 v[176:179], v244, s[12:15], s55 offen sc1
    s_add_u32 s55, s55, 4096
    buffer_load_dwordx4 v[180:183], v244, s[12:15], s52 offen sc1
    s_add_u32 s52, s52, 4096
    buffer_load_dwordx4 v[184:187], v244, s[12:15], s53 offen sc1
    s_add_u32 s53, s53, 4096
    buffer_load_dwordx4 v[188:191], v244, s[12:15], s54 offen sc1
    s_add_u32 s54, s54, 4096
    buffer_load_dwordx4 v[192:195], v244, s[12:15], s55 offen sc1
    s_add_u32 s55, s55, 4096
    v_and_b32 v2, 31, v1
    v_lshrrev_b32 v3, 1, v2
    v_xor_b32 v3, v3, v2
    v_and_b32 v3, 4, v3
    v_mul_u32_u24 v3, 3, v3
    v_xor_b32 v2, v2, v3
    v_lshrrev_b32 v3, 1, v2
    v_lshrrev_b32 v247, 5, v1
    v_xor_b32 v3, v3, v247
    v_and_b32 v3, 7, v3
    v_lshlrev_b32 v3, 4, v3
    v_lshl_add_u32 v247, v2, 7, v3
    v_add_u32 v247, s36, v247
    v_xor_b32 v248, 32, v247
    v_xor_b32 v249, 64, v247
    v_xor_b32 v250, 96, v247
    s_lshr_b32 s48, s26, 3
    s_lshl_b32 s47, s25, 2
    s_add_u32 s48, s48, s47
    s_lshl_b32 s48, s48, 7
    s_lshl_b32 s47, s24, 5
    s_add_u32 s46, s48, s47
    s_mul_i32 s47, s24, 28
    s_add_u32 s48, s48, s47
    s_mov_b32 s48, s49
    s_and_b32 s47, s26, 7
    s_lshl_b32 s47, s47, 7
    s_add_u32 s47, s47, 8192
    v_lshlrev_b32 v237, 2, v1
    v_mov_b32 v238, s48
    v_add_u32 v239, s48, v237
    v_cmp_gt_u32 vcc, 0, v1
    s_nop 1
    v_cndmask_b32 v238, v238, v239, vcc
    v_subrev_u32 v237, 128, v237
    v_add_u32 v239, s47, v237
    v_cmp_gt_u32 vcc, 64, v237
    s_nop 1
    v_cndmask_b32 v238, v238, v239, vcc
    v_subrev_u32 v237, 64, v237
    v_add_u32 v239, s46, v237
    v_cmp_gt_u32 vcc, 0, v237
    s_nop 1
    v_cndmask_b32 v238, v238, v239, vcc
    v_subrev_u32 v237, 32, v237
    v_add_u32 v239, s49, v237
    v_cmp_gt_u32 vcc, 8, v237
    s_nop 1
    v_cndmask_b32 v238, v238, v239, vcc
    s_mov_b32 s48, 28315648
    v_mov_b32 v3, v238
    s_setprio 0
    ds_read_b128 v[196:199], v247 offset:0
    ds_read_b128 v[200:203], v247 offset:4096
    ds_read_b128 v[204:207], v248 offset:0
    ds_read_b128 v[208:211], v248 offset:4096
    ds_read_b128 v[212:215], v249 offset:0
    ds_read_b128 v[216:219], v249 offset:4096
    ds_read_b128 v[220:223], v250 offset:0
    ds_read_b128 v[224:227], v250 offset:4096
    s_waitcnt lgkmcnt(0)
    s_mov_b32 m0, s36
    s_add_u32 s57, s56, 0
    buffer_load_dwordx4 v245, s[16:19], s57 offen offset:0 sc1 lds
    buffer_load_dwordx4 v246, s[16:19], s57 offen offset:1024 sc1 lds
    s_add_u32 s57, s56, 63488
    buffer_load_dwordx4 v245, s[16:19], s57 offen offset:2048 sc1 lds
    buffer_load_dwordx4 v246, s[16:19], s57 offen offset:3072 sc1 lds
    s_mov_b32 m0, s37
    s_add_u32 s57, s56, 131072
    buffer_load_dwordx4 v245, s[16:19], s57 offen offset:0 sc1 lds
    buffer_load_dwordx4 v246, s[16:19], s57 offen offset:1024 sc1 lds
    s_add_u32 s57, s56, 194560
    buffer_load_dwordx4 v245, s[16:19], s57 offen offset:2048 sc1 lds
    buffer_load_dwordx4 v246, s[16:19], s57 offen offset:3072 sc1 lds
    s_add_u32 s56, s56, 128
    s_waitcnt vmcnt(23)
    v_mfma_f32_32x32x16_bf16 v[4:19], v[132:135], v[196:199], 0
    v_mfma_f32_32x32x16_bf16 v[20:35], v[132:135], v[200:203], 0
    buffer_load_dwordx4 v[132:135], v244, s[12:15], s52 offen sc1
    s_add_u32 s52, s52, 4096
    s_waitcnt vmcnt(23)
    v_mfma_f32_32x32x16_bf16 v[36:51], v[136:139], v[196:199], 0
    v_mfma_f32_32x32x16_bf16 v[52:67], v[136:139], v[200:203], 0
    buffer_load_dwordx4 v[136:139], v244, s[12:15], s53 offen sc1
    s_add_u32 s53, s53, 4096
    s_waitcnt vmcnt(23)
    v_mfma_f32_32x32x16_bf16 v[68:83], v[140:143], v[196:199], 0
    v_mfma_f32_32x32x16_bf16 v[84:99], v[140:143], v[200:203], 0
    buffer_load_dwordx4 v[140:143], v244, s[12:15], s54 offen sc1
    s_add_u32 s54, s54, 4096
    s_waitcnt vmcnt(23)
    v_mfma_f32_32x32x16_bf16 v[100:115], v[144:147], v[196:199], 0
    v_mfma_f32_32x32x16_bf16 v[116:131], v[144:147], v[200:203], 0
    buffer_load_dwordx4 v[144:147], v244, s[12:15], s55 offen sc1
    s_add_u32 s55, s55, 4096
    s_waitcnt vmcnt(23)
    v_mfma_f32_32x32x16_bf16 v[4:19], v[148:151], v[204:207], v[4:19]
    v_mfma_f32_32x32x16_bf16 v[20:35], v[148:151], v[208:211], v[20:35]
    buffer_load_dwordx4 v[148:151], v244, s[12:15], s52 offen sc1
    s_add_u32 s52, s52, 4096
    s_waitcnt vmcnt(23)
    v_mfma_f32_32x32x16_bf16 v[36:51], v[152:155], v[204:207], v[36:51]
    v_mfma_f32_32x32x16_bf16 v[52:67], v[152:155], v[208:211], v[52:67]
    buffer_load_dwordx4 v[152:155], v244, s[12:15], s53 offen sc1
    s_add_u32 s53, s53, 4096
    s_waitcnt vmcnt(23)
    v_mfma_f32_32x32x16_bf16 v[68:83], v[156:159], v[204:207], v[68:83]
    v_mfma_f32_32x32x16_bf16 v[84:99], v[156:159], v[208:211], v[84:99]
    buffer_load_dwordx4 v[156:159], v244, s[12:15], s54 offen sc1
    s_add_u32 s54, s54, 4096
    s_waitcnt vmcnt(23)
    v_mfma_f32_32x32x16_bf16 v[100:115], v[160:163], v[204:207], v[100:115]
    v_mfma_f32_32x32x16_bf16 v[116:131], v[160:163], v[208:211], v[116:131]
    buffer_load_dwordx4 v[160:163], v244, s[12:15], s55 offen sc1
    s_add_u32 s55, s55, 4096
    s_waitcnt vmcnt(23)
    v_mfma_f32_32x32x16_bf16 v[4:19], v[164:167], v[212:215], v[4:19]
    s_waitcnt vmcnt(8)
    ds_read_b128 v[228:231], v247 offset:0
    ds_read_b128 v[232:235], v247 offset:4096
    v_mfma_f32_32x32x16_bf16 v[20:35], v[164:167], v[216:219], v[20:35]
    buffer_load_dwordx4 v[164:167], v244, s[12:15], s52 offen sc1
    s_add_u32 s52, s52, 4096
    v_mfma_f32_32x32x16_bf16 v[36:51], v[168:171], v[212:215], v[36:51]
    ds_read_b128 v[236:239], v248 offset:0
    ds_read_b128 v[240:243], v248 offset:4096
    v_mfma_f32_32x32x16_bf16 v[52:67], v[168:171], v[216:219], v[52:67]
    buffer_load_dwordx4 v[168:171], v244, s[12:15], s53 offen sc1
    s_add_u32 s53, s53, 4096
    v_mfma_f32_32x32x16_bf16 v[68:83], v[172:175], v[212:215], v[68:83]
    ds_read_b128 v[196:199], v249 offset:0
    ds_read_b128 v[200:203], v249 offset:4096
    v_mfma_f32_32x32x16_bf16 v[84:99], v[172:175], v[216:219], v[84:99]
    buffer_load_dwordx4 v[172:175], v244, s[12:15], s54 offen sc1
    s_add_u32 s54, s54, 4096
    v_mfma_f32_32x32x16_bf16 v[100:115], v[176:179], v[212:215], v[100:115]
    ds_read_b128 v[204:207], v250 offset:0
    ds_read_b128 v[208:211], v250 offset:4096
    v_mfma_f32_32x32x16_bf16 v[116:131], v[176:179], v[216:219], v[116:131]
    buffer_load_dwordx4 v[176:179], v244, s[12:15], s55 offen sc1
    s_add_u32 s55, s55, 4096
    v_mfma_f32_32x32x16_bf16 v[4:19], v[180:183], v[220:223], v[4:19]
    s_waitcnt lgkmcnt(0)
    s_mov_b32 m0, s36
    s_add_u32 s57, s56, 0
    buffer_load_dwordx4 v245, s[16:19], s57 offen offset:0 sc1 lds
    buffer_load_dwordx4 v246, s[16:19], s57 offen offset:1024 sc1 lds
    v_mfma_f32_32x32x16_bf16 v[20:35], v[180:183], v[224:227], v[20:35]
    buffer_load_dwordx4 v[180:183], v244, s[12:15], s52 offen sc1
    s_add_u32 s52, s52, 4096
    v_mfma_f32_32x32x16_bf16 v[36:51], v[184:187], v[220:223], v[36:51]
    s_add_u32 s57, s56, 63488
    buffer_load_dwordx4 v245, s[16:19], s57 offen offset:2048 sc1 lds
    buffer_load_dwordx4 v246, s[16:19], s57 offen offset:3072 sc1 lds
    v_mfma_f32_32x32x16_bf16 v[52:67], v[184:187], v[224:227], v[52:67]
    buffer_load_dwordx4 v[184:187], v244, s[12:15], s53 offen sc1
    s_add_u32 s53, s53, 4096
    v_mfma_f32_32x32x16_bf16 v[68:83], v[188:191], v[220:223], v[68:83]
    s_mov_b32 m0, s37
    s_add_u32 s57, s56, 131072
    buffer_load_dwordx4 v245, s[16:19], s57 offen offset:0 sc1 lds
    buffer_load_dwordx4 v246, s[16:19], s57 offen offset:1024 sc1 lds
    v_mfma_f32_32x32x16_bf16 v[84:99], v[188:191], v[224:227], v[84:99]
    buffer_load_dwordx4 v[188:191], v244, s[12:15], s54 offen sc1
    s_add_u32 s54, s54, 4096
    v_mfma_f32_32x32x16_bf16 v[100:115], v[192:195], v[220:223], v[100:115]
    s_add_u32 s57, s56, 194560
    buffer_load_dwordx4 v245, s[16:19], s57 offen offset:2048 sc1 lds
    buffer_load_dwordx4 v246, s[16:19], s57 offen offset:3072 sc1 lds
    s_add_u32 s56, s56, 128
    v_mfma_f32_32x32x16_bf16 v[116:131], v[192:195], v[224:227], v[116:131]
    buffer_load_dwordx4 v[192:195], v244, s[12:15], s55 offen sc1
    s_add_u32 s55, s55, 4096
    s_mov_b32 s60, 0
L_pa_g_loop:
    s_cmp_eq_u32 s60, 1
    s_cselect_b32 s66, 0x30000, s36
    s_cselect_b32 s67, 0x30000, s37
    s_waitcnt vmcnt(23)
    v_mfma_f32_32x32x16_bf16 v[4:19], v[132:135], v[228:231], v[4:19]
    v_mfma_f32_32x32x16_bf16 v[20:35], v[132:135], v[232:235], v[20:35]
    buffer_load_dwordx4 v[132:135], v244, s[12:15], s52 offen sc1
    s_add_u32 s52, s52, 4096
    s_waitcnt vmcnt(23)
    v_mfma_f32_32x32x16_bf16 v[36:51], v[136:139], v[228:231], v[36:51]
    v_mfma_f32_32x32x16_bf16 v[52:67], v[136:139], v[232:235], v[52:67]
    buffer_load_dwordx4 v[136:139], v244, s[12:15], s53 offen sc1
    s_add_u32 s53, s53, 4096
    s_waitcnt vmcnt(23)
    v_mfma_f32_32x32x16_bf16 v[68:83], v[140:143], v[228:231], v[68:83]
    v_mfma_f32_32x32x16_bf16 v[84:99], v[140:143], v[232:235], v[84:99]
    buffer_load_dwordx4 v[140:143], v244, s[12:15], s54 offen sc1
    s_add_u32 s54, s54, 4096
    s_waitcnt vmcnt(23)
    v_mfma_f32_32x32x16_bf16 v[100:115], v[144:147], v[228:231], v[100:115]
    v_mfma_f32_32x32x16_bf16 v[116:131], v[144:147], v[232:235], v[116:131]
    buffer_load_dwordx4 v[144:147], v244, s[12:15], s55 offen sc1
    s_add_u32 s55, s55, 4096
    s_waitcnt vmcnt(23)
    v_mfma_f32_32x32x16_bf16 v[4:19], v[148:151], v[236:239], v[4:19]
    v_mfma_f32_32x32x16_bf16 v[20:35], v[148:151], v[240:243], v[20:35]
    buffer_load_dwordx4 v[148:151], v244, s[12:15], s52 offen sc1
    s_add_u32 s52, s52, 4096
    s_waitcnt vmcnt(23)
    v_mfma_f32_32x32x16_bf16 v[36:51], v[152:155], v[236:239], v[36:51]
    v_mfma_f32_32x32x16_bf16 v[52:67], v[152:155], v[240:243], v[52:67]
    buffer_load_dwordx4 v[152:155], v244, s[12:15], s53 offen sc1
    s_add_u32 s53, s53, 4096
    s_waitcnt vmcnt(23)
    v_mfma_f32_32x32x16_bf16 v[68:83], v[156:159], v[236:239], v[68:83]
    v_mfma_f32_32x32x16_bf16 v[84:99], v[156:159], v[240:243], v[84:99]
    buffer_load_dwordx4 v[156:159], v244, s[12:15], s54 offen sc1
    s_add_u32 s54, s54, 4096
    s_waitcnt vmcnt(23)
    v_mfma_f32_32x32x16_bf16 v[100:115], v[160:163], v[236:239], v[100:115]
    v_mfma_f32_32x32x16_bf16 v[116:131], v[160:163], v[240:243], v[116:131]
    buffer_load_dwordx4 v[160:163], v244, s[12:15], s55 offen sc1
    s_add_u32 s55, s55, 4096
    s_waitcnt vmcnt(23)
    v_mfma_f32_32x32x16_bf16 v[4:19], v[164:167], v[196:199], v[4:19]
    s_waitcnt vmcnt(9)
    ds_read_b128 v[212:215], v247 offset:0
    ds_read_b128 v[216:219], v247 offset:4096
    v_mfma_f32_32x32x16_bf16 v[20:35], v[164:167], v[200:203], v[20:35]
    buffer_load_dwordx4 v[164:167], v244, s[12:15], s52 offen sc1
    s_add_u32 s52, s52, 4096
    v_mfma_f32_32x32x16_bf16 v[36:51], v[168:171], v[196:199], v[36:51]
    ds_read_b128 v[220:223], v248 offset:0
    ds_read_b128 v[224:227], v248 offset:4096
    v_mfma_f32_32x32x16_bf16 v[52:67], v[168:171], v[200:203], v[52:67]
    buffer_load_dwordx4 v[168:171], v244, s[12:15], s53 offen sc1
    s_add_u32 s53, s53, 4096
    v_mfma_f32_32x32x16_bf16 v[68:83], v[172:175], v[196:199], v[68:83]
    ds_read_b128 v[228:231], v249 offset:0
    ds_read_b128 v[232:235], v249 offset:4096
    v_mfma_f32_32x32x16_bf16 v[84:99], v[172:175], v[200:203], v[84:99]
    buffer_load_dwordx4 v[172:175], v244, s[12:15], s54 offen sc1
    s_add_u32 s54, s54, 4096
    v_mfma_f32_32x32x16_bf16 v[100:115], v[176:179], v[196:199], v[100:115]
    ds_read_b128 v[236:239], v250 offset:0
    ds_read_b128 v[240:243], v250 offset:4096
    v_mfma_f32_32x32x16_bf16 v[116:131], v[176:179], v[200:203], v[116:131]
    buffer_load_dwordx4 v[176:179], v244, s[12:15], s55 offen sc1
    s_add_u32 s55, s55, 4096
    v_mfma_f32_32x32x16_bf16 v[4:19], v[180:183], v[204:207], v[4:19]
    s_waitcnt lgkmcnt(0)
    s_mov_b32 m0, s36
    s_add_u32 s57, s56, 0
    buffer_load_dwordx4 v245, s[16:19], s57 offen offset:0 sc1 lds
    buffer_load_dwordx4 v246, s[16:19], s57 offen offset:1024 sc1 lds
    v_mfma_f32_32x32x16_bf16 v[20:35], v[180:183], v[208:211], v[20:35]
    buffer_load_dwordx4 v[180:183], v244, s[12:15], s52 offen sc1
    s_add_u32 s52, s52, 4096
    v_mfma_f32_32x32x16_bf16 v[36:51], v[184:187], v[204:207], v[36:51]
    s_add_u32 s57, s56, 63488
    buffer_load_dwordx4 v245, s[16:19], s57 offen offset:2048 sc1 lds
    buffer_load_dwordx4 v246, s[16:19], s57 offen offset:3072 sc1 lds
    v_mfma_f32_32x32x16_bf16 v[52:67], v[184:187], v[208:211], v[52:67]
    buffer_load_dwordx4 v[184:187], v244, s[12:15], s53 offen sc1
    s_add_u32 s53, s53, 4096
    v_mfma_f32_32x32x16_bf16 v[68:83], v[188:191], v[204:207], v[68:83]
    s_mov_b32 m0, s37
    s_add_u32 s57, s56, 131072
    buffer_load_dwordx4 v245, s[16:19], s57 offen offset:0 sc1 lds
    buffer_load_dwordx4 v246, s[16:19], s57 offen offset:1024 sc1 lds
    v_mfma_f32_32x32x16_bf16 v[84:99], v[188:191], v[208:211], v[84:99]
    buffer_load_dwordx4 v[188:191], v244, s[12:15], s54 offen sc1
    s_add_u32 s54, s54, 4096
    s_waitcnt vmcnt(21)
    v_mfma_f32_32x32x16_bf16 v[100:115], v[192:195], v[204:207], v[100:115]
    s_add_u32 s57, s56, 194560
    buffer_load_dwordx4 v245, s[16:19], s57 offen offset:2048 sc1 lds
    buffer_load_dwordx4 v246, s[16:19], s57 offen offset:3072 sc1 lds
    s_add_u32 s56, s56, 128
    v_mfma_f32_32x32x16_bf16 v[116:131], v[192:195], v[208:211], v[116:131]
    buffer_load_dwordx4 v[192:195], v244, s[12:15], s55 offen sc1
    s_add_u32 s55, s55, 4096
    s_waitcnt vmcnt(23)
    v_mfma_f32_32x32x16_bf16 v[4:19], v[132:135], v[212:215], v[4:19]
    v_mfma_f32_32x32x16_bf16 v[20:35], v[132:135], v[216:219], v[20:35]
    buffer_load_dwordx4 v[132:135], v244, s[12:15], s52 offen sc1
    s_add_u32 s52, s52, 4096
    s_waitcnt vmcnt(23)
    v_mfma_f32_32x32x16_bf16 v[36:51], v[136:139], v[212:215], v[36:51]
    v_mfma_f32_32x32x16_bf16 v[52:67], v[136:139], v[216:219], v[52:67]
    buffer_load_dwordx4 v[136:139], v244, s[12:15], s53 offen sc1
    s_add_u32 s53, s53, 4096
    s_waitcnt vmcnt(23)
    v_mfma_f32_32x32x16_bf16 v[68:83], v[140:143], v[212:215], v[68:83]
    v_mfma_f32_32x32x16_bf16 v[84:99], v[140:143], v[216:219], v[84:99]
    buffer_load_dwordx4 v[140:143], v244, s[12:15], s54 offen sc1
    s_add_u32 s54, s54, 4096
    s_waitcnt vmcnt(23)
    v_mfma_f32_32x32x16_bf16 v[100:115], v[144:147], v[212:215], v[100:115]
    v_mfma_f32_32x32x16_bf16 v[116:131], v[144:147], v[216:219], v[116:131]
    buffer_load_dwordx4 v[144:147], v244, s[12:15], s55 offen sc1
    s_add_u32 s55, s55, 4096
    s_waitcnt vmcnt(23)
    v_mfma_f32_32x32x16_bf16 v[4:19], v[148:151], v[220:223], v[4:19]
    v_mfma_f32_32x32x16_bf16 v[20:35], v[148:151], v[224:227], v[20:35]
    buffer_load_dwordx4 v[148:151], v244, s[12:15], s52 offen sc1
    s_add_u32 s52, s52, 4096
    s_waitcnt vmcnt(23)
    v_mfma_f32_32x32x16_bf16 v[36:51], v[152:155], v[220:223], v[36:51]
    v_mfma_f32_32x32x16_bf16 v[52:67], v[152:155], v[224:227], v[52:67]
    buffer_load_dwordx4 v[152:155], v244, s[12:15], s53 offen sc1
    s_add_u32 s53, s53, 4096
    s_waitcnt vmcnt(23)
    v_mfma_f32_32x32x16_bf16 v[68:83], v[156:159], v[220:223], v[68:83]
    v_mfma_f32_32x32x16_bf16 v[84:99], v[156:159], v[224:227], v[84:99]
    buffer_load_dwordx4 v[156:159], v244, s[12:15], s54 offen sc1
    s_add_u32 s54, s54, 4096
    s_waitcnt vmcnt(23)
    v_mfma_f32_32x32x16_bf16 v[100:115], v[160:163], v[220:223], v[100:115]
    v_mfma_f32_32x32x16_bf16 v[116:131], v[160:163], v[224:227], v[116:131]
    buffer_load_dwordx4 v[160:163], v244, s[12:15], s55 offen sc1
    s_add_u32 s55, s55, 4096
    s_waitcnt vmcnt(23)
    v_mfma_f32_32x32x16_bf16 v[4:19], v[164:167], v[228:231], v[4:19]
    s_waitcnt vmcnt(9)
    ds_read_b128 v[196:199], v247 offset:0
    ds_read_b128 v[200:203], v247 offset:4096
    v_mfma_f32_32x32x16_bf16 v[20:35], v[164:167], v[232:235], v[20:35]
    buffer_load_dwordx4 v[164:167], v244, s[12:15], s52 offen sc1
    s_add_u32 s52, s52, 4096
    v_mfma_f32_32x32x16_bf16 v[36:51], v[168:171], v[228:231], v[36:51]
    ds_read_b128 v[204:207], v248 offset:0
    ds_read_b128 v[208:211], v248 offset:4096
    v_mfma_f32_32x32x16_bf16 v[52:67], v[168:171], v[232:235], v[52:67]
    buffer_load_dwordx4 v[168:171], v244, s[12:15], s53 offen sc1
    s_add_u32 s53, s53, 4096
    v_mfma_f32_32x32x16_bf16 v[68:83], v[172:175], v[228:231], v[68:83]
    ds_read_b128 v[212:215], v249 offset:0
    ds_read_b128 v[216:219], v249 offset:4096
    v_mfma_f32_32x32x16_bf16 v[84:99], v[172:175], v[232:235], v[84:99]
    buffer_load_dwordx4 v[172:175], v244, s[12:15], s54 offen sc1
    s_add_u32 s54, s54, 4096
    v_mfma_f32_32x32x16_bf16 v[100:115], v[176:179], v[228:231], v[100:115]
    ds_read_b128 v[220:223], v250 offset:0
    ds_read_b128 v[224:227], v250 offset:4096
    v_mfma_f32_32x32x16_bf16 v[116:131], v[176:179], v[232:235], v[116:131]
    buffer_load_dwordx4 v[176:179], v244, s[12:15], s55 offen sc1
    s_add_u32 s55, s55, 4096
    v_mfma_f32_32x32x16_bf16 v[4:19], v[180:183], v[236:239], v[4:19]
    s_waitcnt lgkmcnt(0)
    s_mov_b32 m0, s36
    s_add_u32 s57, s56, 0
    buffer_load_dwordx4 v245, s[16:19], s57 offen offset:0 sc1 lds
    buffer_load_dwordx4 v246, s[16:19], s57 offen offset:1024 sc1 lds
    v_mfma_f32_32x32x16_bf16 v[20:35], v[180:183], v[240:243], v[20:35]
    buffer_load_dwordx4 v[180:183], v244, s[12:15], s52 offen sc1
    s_add_u32 s52, s52, 4096
    v_mfma_f32_32x32x16_bf16 v[36:51], v[184:187], v[236:239], v[36:51]
    s_add_u32 s57, s56, 63488
    buffer_load_dwordx4 v245, s[16:19], s57 offen offset:2048 sc1 lds
    buffer_load_dwordx4 v246, s[16:19], s57 offen offset:3072 sc1 lds
    v_mfma_f32_32x32x16_bf16 v[52:67], v[184:187], v[240:243], v[52:67]
    buffer_load_dwordx4 v[184:187], v244, s[12:15], s53 offen sc1
    s_add_u32 s53, s53, 4096
    v_mfma_f32_32x32x16_bf16 v[68:83], v[188:191], v[236:239], v[68:83]
    s_mov_b32 m0, s37
    s_add_u32 s57, s56, 131072
    buffer_load_dwordx4 v245, s[16:19], s57 offen offset:0 sc1 lds
    buffer_load_dwordx4 v246, s[16:19], s57 offen offset:1024 sc1 lds
    v_mfma_f32_32x32x16_bf16 v[84:99], v[188:191], v[240:243], v[84:99]
    buffer_load_dwordx4 v[188:191], v244, s[12:15], s54 offen sc1
    s_add_u32 s54, s54, 4096
    s_waitcnt vmcnt(21)
    v_mfma_f32_32x32x16_bf16 v[100:115], v[192:195], v[236:239], v[100:115]
    s_add_u32 s57, s56, 194560
    buffer_load_dwordx4 v245, s[16:19], s57 offen offset:2048 sc1 lds
    buffer_load_dwordx4 v246, s[16:19], s57 offen offset:3072 sc1 lds
    s_add_u32 s56, s56, 128
    v_mfma_f32_32x32x16_bf16 v[116:131], v[192:195], v[240:243], v[116:131]
    buffer_load_dwordx4 v[192:195], v244, s[12:15], s55 offen sc1
    s_add_u32 s55, s55, 4096
    s_waitcnt vmcnt(23)
    v_mfma_f32_32x32x16_bf16 v[4:19], v[132:135], v[196:199], v[4:19]
    v_mfma_f32_32x32x16_bf16 v[20:35], v[132:135], v[200:203], v[20:35]
    buffer_load_dwordx4 v[132:135], v244, s[12:15], s52 offen sc1
    s_add_u32 s52, s52, 4096
    s_waitcnt vmcnt(23)
    v_mfma_f32_32x32x16_bf16 v[36:51], v[136:139], v[196:199], v[36:51]
    v_mfma_f32_32x32x16_bf16 v[52:67], v[136:139], v[200:203], v[52:67]
    buffer_load_dwordx4 v[136:139], v244, s[12:15], s53 offen sc1
    s_add_u32 s53, s53, 4096
    s_waitcnt vmcnt(23)
    v_mfma_f32_32x32x16_bf16 v[68:83], v[140:143], v[196:199], v[68:83]
    v_mfma_f32_32x32x16_bf16 v[84:99], v[140:143], v[200:203], v[84:99]
    buffer_load_dwordx4 v[140:143], v244, s[12:15], s54 offen sc1
    s_add_u32 s54, s54, 4096
    s_waitcnt vmcnt(23)
    v_mfma_f32_32x32x16_bf16 v[100:115], v[144:147], v[196:199], v[100:115]
    v_mfma_f32_32x32x16_bf16 v[116:131], v[144:147], v[200:203], v[116:131]
    buffer_load_dwordx4 v[144:147], v244, s[12:15], s55 offen sc1
    s_add_u32 s55, s55, 4096
    s_waitcnt vmcnt(23)
    v_mfma_f32_32x32x16_bf16 v[4:19], v[148:151], v[204:207], v[4:19]
    v_mfma_f32_32x32x16_bf16 v[20:35], v[148:151], v[208:211], v[20:35]
    buffer_load_dwordx4 v[148:151], v244, s[12:15], s52 offen sc1
    s_add_u32 s52, s52, 4096
    s_waitcnt vmcnt(23)
    v_mfma_f32_32x32x16_bf16 v[36:51], v[152:155], v[204:207], v[36:51]
    v_mfma_f32_32x32x16_bf16 v[52:67], v[152:155], v[208:211], v[52:67]
    buffer_load_dwordx4 v[152:155], v244, s[12:15], s53 offen sc1
    s_add_u32 s53, s53, 4096
    s_waitcnt vmcnt(23)
    v_mfma_f32_32x32x16_bf16 v[68:83], v[156:159], v[204:207], v[68:83]
    v_mfma_f32_32x32x16_bf16 v[84:99], v[156:159], v[208:211], v[84:99]
    buffer_load_dwordx4 v[156:159], v244, s[12:15], s54 offen sc1
    s_add_u32 s54, s54, 4096
    s_waitcnt vmcnt(23)
    v_mfma_f32_32x32x16_bf16 v[100:115], v[160:163], v[204:207], v[100:115]
    v_mfma_f32_32x32x16_bf16 v[116:131], v[160:163], v[208:211], v[116:131]
    buffer_load_dwordx4 v[160:163], v244, s[12:15], s55 offen sc1
    s_add_u32 s55, s55, 4096
    s_waitcnt vmcnt(23)
    v_mfma_f32_32x32x16_bf16 v[4:19], v[164:167], v[212:215], v[4:19]
    s_waitcnt vmcnt(9)
    ds_read_b128 v[228:231], v247 offset:0
    ds_read_b128 v[232:235], v247 offset:4096
    v_mfma_f32_32x32x16_bf16 v[20:35], v[164:167], v[216:219], v[20:35]
    buffer_load_dwordx4 v[164:167], v244, s[12:15], s52 offen sc1
    s_add_u32 s52, s52, 4096
    v_mfma_f32_32x32x16_bf16 v[36:51], v[168:171], v[212:215], v[36:51]
    ds_read_b128 v[236:239], v248 offset:0
    ds_read_b128 v[240:243], v248 offset:4096
    v_mfma_f32_32x32x16_bf16 v[52:67], v[168:171], v[216:219], v[52:67]
    buffer_load_dwordx4 v[168:171], v244, s[12:15], s53 offen sc1
    s_add_u32 s53, s53, 4096
    v_mfma_f32_32x32x16_bf16 v[68:83], v[172:175], v[212:215], v[68:83]
    ds_read_b128 v[196:199], v249 offset:0
    ds_read_b128 v[200:203], v249 offset:4096
    v_mfma_f32_32x32x16_bf16 v[84:99], v[172:175], v[216:219], v[84:99]
    buffer_load_dwordx4 v[172:175], v244, s[12:15], s54 offen sc1
    s_add_u32 s54, s54, 4096
    v_mfma_f32_32x32x16_bf16 v[100:115], v[176:179], v[212:215], v[100:115]
    ds_read_b128 v[204:207], v250 offset:0
    ds_read_b128 v[208:211], v250 offset:4096
    v_mfma_f32_32x32x16_bf16 v[116:131], v[176:179], v[216:219], v[116:131]
    buffer_load_dwordx4 v[176:179], v244, s[12:15], s55 offen sc1
    s_add_u32 s55, s55, 4096
    v_mfma_f32_32x32x16_bf16 v[4:19], v[180:183], v[220:223], v[4:19]
    s_waitcnt lgkmcnt(0)
    s_mov_b32 m0, s66
    s_add_u32 s57, s56, 0
    buffer_load_dwordx4 v245, s[16:19], s57 offen offset:0 sc1 lds
    buffer_load_dwordx4 v246, s[16:19], s57 offen offset:1024 sc1 lds
    v_mfma_f32_32x32x16_bf16 v[20:35], v[180:183], v[224:227], v[20:35]
    buffer_load_dwordx4 v[180:183], v244, s[12:15], s52 offen sc1
    s_add_u32 s52, s52, 4096
    v_mfma_f32_32x32x16_bf16 v[36:51], v[184:187], v[220:223], v[36:51]
    s_add_u32 s57, s56, 63488
    buffer_load_dwordx4 v245, s[16:19], s57 offen offset:2048 sc1 lds
    buffer_load_dwordx4 v246, s[16:19], s57 offen offset:3072 sc1 lds
    v_mfma_f32_32x32x16_bf16 v[52:67], v[184:187], v[224:227], v[52:67]
    buffer_load_dwordx4 v[184:187], v244, s[12:15], s53 offen sc1
    s_add_u32 s53, s53, 4096
    v_mfma_f32_32x32x16_bf16 v[68:83], v[188:191], v[220:223], v[68:83]
    s_mov_b32 m0, s67
    s_add_u32 s57, s56, 131072
    buffer_load_dwordx4 v245, s[16:19], s57 offen offset:0 sc1 lds
    buffer_load_dwordx4 v246, s[16:19], s57 offen offset:1024 sc1 lds
    v_mfma_f32_32x32x16_bf16 v[84:99], v[188:191], v[224:227], v[84:99]
    buffer_load_dwordx4 v[188:191], v244, s[12:15], s54 offen sc1
    s_add_u32 s54, s54, 4096
    s_waitcnt vmcnt(21)
    v_mfma_f32_32x32x16_bf16 v[100:115], v[192:195], v[220:223], v[100:115]
    s_add_u32 s57, s56, 194560
    buffer_load_dwordx4 v245, s[16:19], s57 offen offset:2048 sc1 lds
    buffer_load_dwordx4 v246, s[16:19], s57 offen offset:3072 sc1 lds
    s_add_u32 s56, s56, 128
    v_mfma_f32_32x32x16_bf16 v[116:131], v[192:195], v[224:227], v[116:131]
    buffer_load_dwordx4 v[192:195], v244, s[12:15], s55 offen sc1
    s_add_u32 s55, s55, 4096
    s_add_u32 s60, s60, 1
    s_cmp_lt_u32 s60, 2
    s_cbranch_scc1 L_pa_g_loop
    s_mov_b32 s48, 28315648
    buffer_load_dword v0, v3, s[12:15], s48 offen sc1
    s_waitcnt vmcnt(24)
    v_mfma_f32_32x32x16_bf16 v[4:19], v[132:135], v[228:231], v[4:19]
    v_mfma_f32_32x32x16_bf16 v[20:35], v[132:135], v[232:235], v[20:35]
    s_waitcnt vmcnt(23)
    v_mfma_f32_32x32x16_bf16 v[36:51], v[136:139], v[228:231], v[36:51]
    v_mfma_f32_32x32x16_bf16 v[52:67], v[136:139], v[232:235], v[52:67]
    s_waitcnt vmcnt(22)
    v_mfma_f32_32x32x16_bf16 v[68:83], v[140:143], v[228:231], v[68:83]
    v_mfma_f32_32x32x16_bf16 v[84:99], v[140:143], v[232:235], v[84:99]
    s_waitcnt vmcnt(21)
    v_mfma_f32_32x32x16_bf16 v[100:115], v[144:147], v[228:231], v[100:115]
    v_mfma_f32_32x32x16_bf16 v[116:131], v[144:147], v[232:235], v[116:131]
    s_waitcnt vmcnt(20)
    v_mfma_f32_32x32x16_bf16 v[4:19], v[148:151], v[236:239], v[4:19]
    v_mfma_f32_32x32x16_bf16 v[20:35], v[148:151], v[240:243], v[20:35]
    s_waitcnt vmcnt(19)
    v_mfma_f32_32x32x16_bf16 v[36:51], v[152:155], v[236:239], v[36:51]
    v_mfma_f32_32x32x16_bf16 v[52:67], v[152:155], v[240:243], v[52:67]
    s_waitcnt vmcnt(18)
    v_mfma_f32_32x32x16_bf16 v[68:83], v[156:159], v[236:239], v[68:83]
    v_mfma_f32_32x32x16_bf16 v[84:99], v[156:159], v[240:243], v[84:99]
    s_waitcnt vmcnt(17)
    v_mfma_f32_32x32x16_bf16 v[100:115], v[160:163], v[236:239], v[100:115]
    v_mfma_f32_32x32x16_bf16 v[116:131], v[160:163], v[240:243], v[116:131]
    s_waitcnt vmcnt(16)
    v_mfma_f32_32x32x16_bf16 v[4:19], v[164:167], v[196:199], v[4:19]
    v_mfma_f32_32x32x16_bf16 v[20:35], v[164:167], v[200:203], v[20:35]
    s_waitcnt vmcnt(15)
    v_mfma_f32_32x32x16_bf16 v[36:51], v[168:171], v[196:199], v[36:51]
    v_mfma_f32_32x32x16_bf16 v[52:67], v[168:171], v[200:203], v[52:67]
    s_waitcnt vmcnt(14)
    v_mfma_f32_32x32x16_bf16 v[68:83], v[172:175], v[196:199], v[68:83]
    v_mfma_f32_32x32x16_bf16 v[84:99], v[172:175], v[200:203], v[84:99]
    s_waitcnt vmcnt(13)
    v_mfma_f32_32x32x16_bf16 v[100:115], v[176:179], v[196:199], v[100:115]
    v_mfma_f32_32x32x16_bf16 v[116:131], v[176:179], v[200:203], v[116:131]
    s_waitcnt vmcnt(10)
    v_mfma_f32_32x32x16_bf16 v[4:19], v[180:183], v[204:207], v[4:19]
    v_mfma_f32_32x32x16_bf16 v[20:35], v[180:183], v[208:211], v[20:35]
    s_waitcnt vmcnt(7)
    v_mfma_f32_32x32x16_bf16 v[36:51], v[184:187], v[204:207], v[36:51]
    v_mfma_f32_32x32x16_bf16 v[52:67], v[184:187], v[208:211], v[52:67]
    s_waitcnt vmcnt(4)
    v_mfma_f32_32x32x16_bf16 v[68:83], v[188:191], v[204:207], v[68:83]
    v_mfma_f32_32x32x16_bf16 v[84:99], v[188:191], v[208:211], v[84:99]
    s_waitcnt vmcnt(1)
    v_mfma_f32_32x32x16_bf16 v[100:115], v[192:195], v[204:207], v[100:115]
    v_mfma_f32_32x32x16_bf16 v[116:131], v[192:195], v[208:211], v[116:131]
    s_setprio 3
    s_lshl_b32 s38, s30, 1
    s_mul_i32 s39, s38, 57344
    s_lshl_b32 s40, s31, 2
    s_add_u32 s40, s40, s24
    s_lshl_b32 s41, s40, 11
    s_add_u32 s39, s39, s41
    s_add_u32 s39, s39, 6815744
    s_add_u32 s42, s39, 57344
    s_mul_i32 s64, s38, 90112
    s_add_u32 s64, s64, s41
    s_add_u32 s64, s64, 14712832
    s_add_u32 s65, s64, 90112
    s_lshl_b32 s66, s30, 12
    s_lshl_b32 s45, s40, 7
    s_add_u32 s66, s66, s45
    s_add_u32 s66, s66, 28442624
    s_lshl_b32 s45, s30, 7
    v_lshlrev_b32 v2, 1, v2
    v_mov_b32 v233, v251
    s_waitcnt vmcnt(0)
    v_cmp_ne_u32 vcc, s11, v0
    s_cbranch_vccz L_pa_g_fl
    s_mov_b32 s47, 0
L_pa_p00:
    buffer_load_dword v0, v3, s[12:15], s48 offen sc1
    s_add_u32 s47, s47, 1
    s_waitcnt vmcnt(0)
    v_cmp_ne_u32 vcc, s11, v0
    s_cbranch_vccz L_pa_p00_ok
    s_cmp_gt_u32 s47, 0x10000
    s_cbranch_scc1 L_pa_p00_ok
    s_sleep 8
    s_branch L_pa_p00
L_pa_p00_ok:
L_pa_g_fl:
    buffer_load_dwordx4 v[132:135], v244, s[12:15], s39 offen sc1
    buffer_load_dwordx4 v[136:139], v244, s[12:15], s39 offen offset:1024 sc1
    buffer_load_dwordx4 v[140:143], v244, s[12:15], s42 offen sc1
    buffer_load_dwordx4 v[144:147], v244, s[12:15], s42 offen offset:1024 sc1
    buffer_load_ushort v148, v2, s[20:23], s45 offen sc1
    buffer_load_ushort v149, v2, s[20:23], s45 offen offset:64 sc1
    s_load_dwordx2 s[6:7], s[0:1], 0
    s_load_dwordx2 s[8:9], s[0:1], 64
    s_lshr_b32 s27, s26, 3
    s_lshl_b32 s28, s25, 2
    s_add_u32 s27, s27, s28
    s_and_b32 s28, s26, 7
    s_and_b32 s29, s24, 1
    s_lshr_b32 s30, s24, 1
    s_lshl_b32 s32, s27, 1
    s_add_u32 s33, s32, s29
    s_xor_b32 s34, s33, 1
    s_lshl_b32 s32, s28, 1
    s_add_u32 s35, s32, s30
    s_xor_b32 s37, s35, 1
    s_mul_i32 s40, s33, 90112
    s_mul_i32 s41, s34, 90112
    s_mul_i32 s42, s35, 90112
    s_mul_i32 s43, s37, 90112
    s_add_u32 s40, s40, 14680064
    s_add_u32 s41, s41, 14680064
    s_add_u32 s42, s42, 20971520
    s_add_u32 s43, s43, 20971520
    s_mul_i32 s31, s24, 14336
    s_add_u32 s31, s31, 32768
    s_lshl_b32 s32, s24, 13
    s_lshl_b32 s44, s33, 15
    s_lshl_b32 s45, s35, 6
    s_add_u32 s44, s44, s45
    s_mov_b32 s49, 0
    s_waitcnt lgkmcnt(0)
    s_add_u32 s54, s42, s31
    s_add_u32 s54, s54, 0
    buffer_load_dwordx4 v[152:155], v244, s[12:15], s54 offen offset:0 sc1
    s_add_u32 s55, s43, s31
    s_add_u32 s55, s55, 0
    buffer_load_dwordx4 v[156:159], v244, s[12:15], s55 offen offset:0 sc1
    buffer_load_dwordx4 v[160:163], v244, s[12:15], s54 offen offset:1024 sc1
    buffer_load_dwordx4 v[164:167], v244, s[12:15], s55 offen offset:1024 sc1
    buffer_load_dwordx4 v[168:171], v244, s[12:15], s54 offen offset:2048 sc1
    buffer_load_dwordx4 v[172:175], v244, s[12:15], s55 offen offset:2048 sc1
    buffer_load_dwordx4 v[176:179], v244, s[12:15], s54 offen offset:3072 sc1
    buffer_load_dwordx4 v[180:183], v244, s[12:15], s55 offen offset:3072 sc1
    s_add_u32 s54, s42, s31
    s_add_u32 s54, s54, 4096
    buffer_load_dwordx4 v[184:187], v244, s[12:15], s54 offen offset:0 sc1
    s_add_u32 s55, s43, s31
    s_add_u32 s55, s55, 4096
    buffer_load_dwordx4 v[188:191], v244, s[12:15], s55 offen offset:0 sc1
    buffer_load_dwordx4 v[192:195], v244, s[12:15], s54 offen offset:1024 sc1
    buffer_load_dwordx4 v[196:199], v244, s[12:15], s55 offen offset:1024 sc1
    buffer_load_dwordx4 v[200:203], v244, s[12:15], s54 offen offset:2048 sc1
    buffer_load_dwordx4 v[204:207], v244, s[12:15], s55 offen offset:2048 sc1
    buffer_load_dwordx4 v[208:211], v244, s[12:15], s54 offen offset:3072 sc1
    buffer_load_dwordx4 v[212:215], v244, s[12:15], s55 offen offset:3072 sc1
    s_add_u32 s54, s42, s31
    s_add_u32 s54, s54, 8192
    buffer_load_dwordx4 v[216:219], v244, s[12:15], s54 offen offset:0 sc1
    s_add_u32 s55, s43, s31
    s_add_u32 s55, s55, 8192
    buffer_load_dwordx4 v[220:223], v244, s[12:15], s55 offen offset:0 sc1
    buffer_load_dwordx4 v[224:227], v244, s[12:15], s54 offen offset:1024 sc1
    buffer_load_dwordx4 v[228:231], v244, s[12:15], s55 offen offset:1024 sc1
    v_add_u32 v232, s36, v244
    v_mov_b32 v234, 0
    s_lshl_b32 s47, s24, 14
    s_add_u32 s47, s47, 1024
    v_add_u32 v235, s47, v244
    ds_write_b128 v232, v[36:39] offset:0
    ds_write_b128 v232, v[40:43] offset:1024
    ds_write_b128 v232, v[44:47] offset:2048
    ds_write_b128 v232, v[48:51] offset:3072
    ds_write_b128 v232, v[52:55] offset:4096
    ds_write_b128 v232, v[56:59] offset:5120
    ds_write_b128 v232, v[60:63] offset:6144
    ds_write_b128 v232, v[64:67] offset:7168
L_pa_g_prog:
    ds_read_b128 v[236:239], v234 offset:80
    s_waitcnt lgkmcnt(0)
    v_min_u32 v236, v236, v237
    v_min3_u32 v236, v236, v238, v239
    v_cmp_gt_u32 vcc, 4, v236
    s_cbranch_vccz L_pa_g_prog_ok
    s_sleep 1
    s_branch L_pa_g_prog
L_pa_g_prog_ok:
    ds_write_b128 v235, v[68:71] offset:0
    ds_write_b128 v235, v[72:75] offset:1024
    ds_write_b128 v235, v[76:79] offset:2048
    ds_write_b128 v235, v[80:83] offset:3072
    ds_write_b128 v235, v[84:87] offset:4096
    ds_write_b128 v235, v[88:91] offset:5120
    ds_write_b128 v235, v[92:95] offset:6144
    ds_write_b128 v235, v[96:99] offset:7168
    ds_write_b128 v235, v[100:103] offset:8192
    ds_write_b128 v235, v[104:107] offset:9216
    ds_write_b128 v235, v[108:111] offset:10240
    ds_write_b128 v235, v[112:115] offset:11264
    ds_write_b128 v235, v[116:119] offset:12288
    ds_write_b128 v235, v[120:123] offset:13312
    s_waitcnt lgkmcnt(12)
    ds_write_b128 v235, v[124:127] offset:14336
    ds_write_b128 v235, v[128:131] offset:15360
    s_add_u32 s47, s24, 3
    s_and_b32 s47, s47, 3
    s_lshl_b32 s47, s47, 13
    s_add_u32 s47, s47, 131072
    v_add_u32 v232, s47, v244
    s_add_u32 s47, s24, 2
    s_and_b32 s47, s47, 3
    s_lshl_b32 s47, s47, 14
    s_add_u32 s47, s47, 1024
    v_add_u32 v2, s47, v244
    s_add_u32 s47, s24, 1
    s_and_b32 s47, s47, 3
    s_lshl_b32 s47, s47, 14
    s_add_u32 s47, s47, 9216
    v_add_u32 v3, s47, v244
    v_mov_b32 v235, 1
    s_waitcnt lgkmcnt(0)
    ds_write_b32 v233, v235 offset:16
L_pa_g_dat:
    ds_read_b128 v[236:239], v234 offset:16
    s_waitcnt lgkmcnt(0)
    v_min_u32 v236, v236, v237
    v_min3_u32 v236, v236, v238, v239
    v_cmp_gt_u32 vcc, 1, v236
    s_cbranch_vccz L_pa_g_dat_ok
    s_sleep 0
    s_branch L_pa_g_dat
L_pa_g_dat_ok:
    ds_read_b128 v[36:39], v232 offset:0
    ds_read_b128 v[40:43], v232 offset:1024
    ds_read_b128 v[44:47], v232 offset:2048
    ds_read_b128 v[48:51], v232 offset:3072
    ds_read_b128 v[52:55], v232 offset:4096
    ds_read_b128 v[56:59], v232 offset:5120
    ds_read_b128 v[60:63], v232 offset:6144
    ds_read_b128 v[64:67], v232 offset:7168
    ds_read_b128 v[68:71], v2 offset:0
    ds_read_b128 v[72:75], v2 offset:1024
    ds_read_b128 v[76:79], v2 offset:2048
    ds_read_b128 v[80:83], v2 offset:3072
    ds_read_b128 v[84:87], v2 offset:4096
    ds_read_b128 v[88:91], v2 offset:5120
    s_waitcnt lgkmcnt(12)
    ds_read_b128 v[92:95], v2 offset:6144
    ds_read_b128 v[96:99], v2 offset:7168
    v_add_f32 v4, v4, v36
    v_add_f32 v5, v5, v37
    v_add_f32 v6, v6, v38
    v_add_f32 v7, v7, v39
    v_add_f32 v8, v8, v40
    v_add_f32 v9, v9, v41
    v_add_f32 v10, v10, v42
    v_add_f32 v11, v11, v43
    s_waitcnt lgkmcnt(13)
    v_add_f32 v12, v12, v44
    v_add_f32 v13, v13, v45
    v_add_f32 v14, v14, v46
    v_add_f32 v15, v15, v47
    s_waitcnt lgkmcnt(12)
    v_add_f32 v16, v16, v48
    v_add_f32 v17, v17, v49
    v_add_f32 v18, v18, v50
    v_add_f32 v19, v19, v51
    s_waitcnt lgkmcnt(11)
    v_add_f32 v20, v20, v52
    v_add_f32 v21, v21, v53
    v_add_f32 v22, v22, v54
    v_add_f32 v23, v23, v55
    s_waitcnt lgkmcnt(10)
    v_add_f32 v24, v24, v56
    v_add_f32 v25, v25, v57
    v_add_f32 v26, v26, v58
    v_add_f32 v27, v27, v59
    s_waitcnt lgkmcnt(9)
    v_add_f32 v28, v28, v60
    v_add_f32 v29, v29, v61
    v_add_f32 v30, v30, v62
    v_add_f32 v31, v31, v63
    s_waitcnt lgkmcnt(8)
    v_add_f32 v32, v32, v64
    v_add_f32 v33, v33, v65
    v_add_f32 v34, v34, v66
    v_add_f32 v35, v35, v67
    ds_read_b128 v[100:103], v3 offset:0
    ds_read_b128 v[104:107], v3 offset:1024
    ds_read_b128 v[108:111], v3 offset:2048
    ds_read_b128 v[112:115], v3 offset:3072
    ds_read_b128 v[116:119], v3 offset:4096
    ds_read_b128 v[120:123], v3 offset:5120
    s_waitcnt lgkmcnt(12)
    ds_read_b128 v[124:127], v3 offset:6144
    ds_read_b128 v[128:131], v3 offset:7168
    v_add_f32 v4, v4, v68
    v_add_f32 v5, v5, v69
    v_add_f32 v6, v6, v70
    v_add_f32 v7, v7, v71
    v_add_f32 v8, v8, v72
    v_add_f32 v9, v9, v73
    v_add_f32 v10, v10, v74
    v_add_f32 v11, v11, v75
    s_waitcnt lgkmcnt(13)
    v_add_f32 v12, v12, v76
    v_add_f32 v13, v13, v77
    v_add_f32 v14, v14, v78
    v_add_f32 v15, v15, v79
    s_waitcnt lgkmcnt(12)
    v_add_f32 v16, v16, v80
    v_add_f32 v17, v17, v81
    v_add_f32 v18, v18, v82
    v_add_f32 v19, v19, v83
    s_waitcnt lgkmcnt(11)
    v_add_f32 v20, v20, v84
    v_add_f32 v21, v21, v85
    v_add_f32 v22, v22, v86
    v_add_f32 v23, v23, v87
    s_waitcnt lgkmcnt(10)
    v_add_f32 v24, v24, v88
    v_add_f32 v25, v25, v89
    v_add_f32 v26, v26, v90
    v_add_f32 v27, v27, v91
    s_waitcnt lgkmcnt(9)
    v_add_f32 v28, v28, v92
    v_add_f32 v29, v29, v93
    v_add_f32 v30, v30, v94
    v_add_f32 v31, v31, v95
    s_waitcnt lgkmcnt(8)
    v_add_f32 v32, v32, v96
    v_add_f32 v33, v33, v97
    v_add_f32 v34, v34, v98
    v_add_f32 v35, v35, v99
    s_waitcnt lgkmcnt(7)
    v_add_f32 v4, v4, v100
    v_add_f32 v5, v5, v101
    v_add_f32 v6, v6, v102
    v_add_f32 v7, v7, v103
    s_waitcnt lgkmcnt(6)
    v_add_f32 v8, v8, v104
    v_add_f32 v9, v9, v105
    v_add_f32 v10, v10, v106
    v_add_f32 v11, v11, v107
    s_waitcnt lgkmcnt(5)
    v_add_f32 v12, v12, v108
    v_add_f32 v13, v13, v109
    v_add_f32 v14, v14, v110
    v_add_f32 v15, v15, v111
    s_waitcnt lgkmcnt(4)
    v_add_f32 v16, v16, v112
    v_add_f32 v17, v17, v113
    v_add_f32 v18, v18, v114
    v_add_f32 v19, v19, v115
    s_waitcnt lgkmcnt(3)
    v_add_f32 v20, v20, v116
    v_add_f32 v21, v21, v117
    v_add_f32 v22, v22, v118
    v_add_f32 v23, v23, v119
    s_waitcnt lgkmcnt(2)
    v_add_f32 v24, v24, v120
    v_add_f32 v25, v25, v121
    v_add_f32 v26, v26, v122
    v_add_f32 v27, v27, v123
    s_waitcnt lgkmcnt(1)
    v_add_f32 v28, v28, v124
    v_add_f32 v29, v29, v125
    v_add_f32 v30, v30, v126
    v_add_f32 v31, v31, v127
    s_waitcnt lgkmcnt(0)
    v_add_f32 v32, v32, v128
    v_add_f32 v33, v33, v129
    v_add_f32 v34, v34, v130
    v_add_f32 v35, v35, v131
    s_waitcnt vmcnt(20)
    v_lshlrev_b32 v148, 16, v148
    v_lshlrev_b32 v149, 16, v149
    v_add_f32 v4, v4, v148
    v_add_f32 v5, v5, v148
    v_add_f32 v6, v6, v148
    v_add_f32 v7, v7, v148
    v_add_f32 v8, v8, v148
    v_add_f32 v9, v9, v148
    v_add_f32 v10, v10, v148
    v_add_f32 v11, v11, v148
    v_add_f32 v12, v12, v148
    v_add_f32 v13, v13, v148
    v_add_f32 v14, v14, v148
    v_add_f32 v15, v15, v148
    v_add_f32 v16, v16, v148
    v_add_f32 v17, v17, v148
    v_add_f32 v18, v18, v148
    v_add_f32 v19, v19, v148
    v_lshlrev_b32 v36, 16, v132
    v_and_b32 v37, 0xffff0000, v132
    v_mul_f32 v4, v4, v36
    v_mul_f32 v5, v5, v37
    v_cvt_pk_bf16_f32 v44, v4, v5
    v_lshlrev_b32 v36, 16, v133
    v_and_b32 v37, 0xffff0000, v133
    v_mul_f32 v6, v6, v36
    v_mul_f32 v7, v7, v37
    v_cvt_pk_bf16_f32 v45, v6, v7
    v_lshlrev_b32 v36, 16, v134
    v_and_b32 v37, 0xffff0000, v134
    v_mul_f32 v8, v8, v36
    v_mul_f32 v9, v9, v37
    v_cvt_pk_bf16_f32 v46, v8, v9
    v_lshlrev_b32 v36, 16, v135
    v_and_b32 v37, 0xffff0000, v135
    v_mul_f32 v10, v10, v36
    v_mul_f32 v11, v11, v37
    v_cvt_pk_bf16_f32 v47, v10, v11
    v_lshlrev_b32 v36, 16, v136
    v_and_b32 v37, 0xffff0000, v136
    v_mul_f32 v12, v12, v36
    v_mul_f32 v13, v13, v37
    v_cvt_pk_bf16_f32 v48, v12, v13
    v_lshlrev_b32 v36, 16, v137
    v_and_b32 v37, 0xffff0000, v137
    v_mul_f32 v14, v14, v36
    v_mul_f32 v15, v15, v37
    v_cvt_pk_bf16_f32 v49, v14, v15
    v_lshlrev_b32 v36, 16, v138
    v_and_b32 v37, 0xffff0000, v138
    v_mul_f32 v16, v16, v36
    v_mul_f32 v17, v17, v37
    v_cvt_pk_bf16_f32 v50, v16, v17
    v_lshlrev_b32 v36, 16, v139
    v_and_b32 v37, 0xffff0000, v139
    v_mul_f32 v18, v18, v36
    v_mul_f32 v19, v19, v37
    v_cvt_pk_bf16_f32 v51, v18, v19
    buffer_store_dwordx4 v[44:47], v244, s[12:15], s64 offen sc1
    buffer_store_dwordx4 v[48:51], v244, s[12:15], s64 offen offset:1024 sc1
    v_add_f32 v20, v20, v149
    v_add_f32 v21, v21, v149
    v_add_f32 v22, v22, v149
    v_add_f32 v23, v23, v149
    v_add_f32 v24, v24, v149
    v_add_f32 v25, v25, v149
    v_add_f32 v26, v26, v149
    v_add_f32 v27, v27, v149
    v_add_f32 v28, v28, v149
    v_add_f32 v29, v29, v149
    v_add_f32 v30, v30, v149
    v_add_f32 v31, v31, v149
    v_add_f32 v32, v32, v149
    v_add_f32 v33, v33, v149
    v_add_f32 v34, v34, v149
    v_add_f32 v35, v35, v149
    v_lshlrev_b32 v36, 16, v140
    v_and_b32 v37, 0xffff0000, v140
    v_mul_f32 v20, v20, v36
    v_mul_f32 v21, v21, v37
    v_cvt_pk_bf16_f32 v52, v20, v21
    v_lshlrev_b32 v36, 16, v141
    v_and_b32 v37, 0xffff0000, v141
    v_mul_f32 v22, v22, v36
    v_mul_f32 v23, v23, v37
    v_cvt_pk_bf16_f32 v53, v22, v23
    v_lshlrev_b32 v36, 16, v142
    v_and_b32 v37, 0xffff0000, v142
    v_mul_f32 v24, v24, v36
    v_mul_f32 v25, v25, v37
    v_cvt_pk_bf16_f32 v54, v24, v25
    v_lshlrev_b32 v36, 16, v143
    v_and_b32 v37, 0xffff0000, v143
    v_mul_f32 v26, v26, v36
    v_mul_f32 v27, v27, v37
    v_cvt_pk_bf16_f32 v55, v26, v27
    v_lshlrev_b32 v36, 16, v144
    v_and_b32 v37, 0xffff0000, v144
    v_mul_f32 v28, v28, v36
    v_mul_f32 v29, v29, v37
    v_cvt_pk_bf16_f32 v56, v28, v29
    v_lshlrev_b32 v36, 16, v145
    v_and_b32 v37, 0xffff0000, v145
    v_mul_f32 v30, v30, v36
    v_mul_f32 v31, v31, v37
    v_cvt_pk_bf16_f32 v57, v30, v31
    v_lshlrev_b32 v36, 16, v146
    v_and_b32 v37, 0xffff0000, v146
    v_mul_f32 v32, v32, v36
    v_mul_f32 v33, v33, v37
    v_cvt_pk_bf16_f32 v58, v32, v33
    v_lshlrev_b32 v36, 16, v147
    v_and_b32 v37, 0xffff0000, v147
    v_mul_f32 v34, v34, v36
    v_mul_f32 v35, v35, v37
    v_cvt_pk_bf16_f32 v59, v34, v35
    buffer_store_dwordx4 v[52:55], v244, s[12:15], s65 offen sc1
    buffer_store_dwordx4 v[56:59], v244, s[12:15], s65 offen offset:1024 sc1
    v_mov_b32 v232, s11
    s_waitcnt vmcnt(0)
    buffer_store_dword v232, off, s[12:15], s66 sc1
    s_branch L_pa_g2
L_pa_idle:
    s_waitcnt vmcnt(0) lgkmcnt(0)
    ds_write_b32 v251, v0 offset:48
    s_cmp_ge_u32 s88, 14
    s_cbranch_scc1 L_pa_b_midb
    v_mul_f32 v68, v52, v52
    v_mul_f32 v69, v53, v53
    v_mul_f32 v70, v54, v54
    v_mul_f32 v71, v55, v55
    v_fma_f32 v68, v68, v119, v118
    v_fma_f32 v69, v69, v119, v118
    v_fma_f32 v70, v70, v119, v118
    v_fma_f32 v71, v71, v119, v118
    v_mul_f32 v68, v68, v52
    v_mul_f32 v69, v69, v53
    v_mul_f32 v70, v70, v54
    v_mul_f32 v71, v71, v55
    v_exp_f32 v68, v68
    v_exp_f32 v69, v69
    v_exp_f32 v70, v70
    v_exp_f32 v71, v71
    v_fma_f32 v68, v68, v117, v117
    v_fma_f32 v69, v69, v117, v117
    v_fma_f32 v70, v70, v117, v117
    v_fma_f32 v71, v71, v117, v117
    v_rcp_f32 v68, v68
    v_rcp_f32 v69, v69
    v_rcp_f32 v70, v70
    v_rcp_f32 v71, v71
    v_mul_f32 v52, v52, v68
    v_mul_f32 v53, v53, v69
    v_mul_f32 v54, v54, v70
    v_mul_f32 v55, v55, v71
    v_cvt_pk_bf16_f32 v80, v52, v53
    v_cvt_pk_bf16_f32 v81, v54, v55
    v_mul_f32 v68, v56, v56
    v_mul_f32 v69, v57, v57
    v_mul_f32 v70, v58, v58
    v_mul_f32 v71, v59, v59
    v_fma_f32 v68, v68, v119, v118
    v_fma_f32 v69, v69, v119, v118
    v_fma_f32 v70, v70, v119, v118
    v_fma_f32 v71, v71, v119, v118
    v_mul_f32 v68, v68, v56
    v_mul_f32 v69, v69, v57
    v_mul_f32 v70, v70, v58
    v_mul_f32 v71, v71, v59
    v_exp_f32 v68, v68
    v_exp_f32 v69, v69
    v_exp_f32 v70, v70
    v_exp_f32 v71, v71
    v_fma_f32 v68, v68, v117, v117
    v_fma_f32 v69, v69, v117, v117
    v_fma_f32 v70, v70, v117, v117
    v_fma_f32 v71, v71, v117, v117
    v_rcp_f32 v68, v68
    v_rcp_f32 v69, v69
    v_rcp_f32 v70, v70
    v_rcp_f32 v71, v71
    v_mul_f32 v56, v56, v68
    v_mul_f32 v57, v57, v69
    v_mul_f32 v58, v58, v70
    v_mul_f32 v59, v59, v71
    v_cvt_pk_bf16_f32 v82, v56, v57
    v_cvt_pk_bf16_f32 v83, v58, v59
    v_mul_f32 v68, v60, v60
    v_mul_f32 v69, v61, v61
    v_mul_f32 v70, v62, v62
    v_mul_f32 v71, v63, v63
    v_fma_f32 v68, v68, v119, v118
    v_fma_f32 v69, v69, v119, v118
    v_fma_f32 v70, v70, v119, v118
    v_fma_f32 v71, v71, v119, v118
    v_mul_f32 v68, v68, v60
    v_mul_f32 v69, v69, v61
    v_mul_f32 v70, v70, v62
    v_mul_f32 v71, v71, v63
    v_exp_f32 v68, v68
    v_exp_f32 v69, v69
    v_exp_f32 v70, v70
    v_exp_f32 v71, v71
    v_fma_f32 v68, v68, v117, v117
    v_fma_f32 v69, v69, v117, v117
    v_fma_f32 v70, v70, v117, v117
    v_fma_f32 v71, v71, v117, v117
    v_rcp_f32 v68, v68
    v_rcp_f32 v69, v69
    v_rcp_f32 v70, v70
    v_rcp_f32 v71, v71
    v_mul_f32 v60, v60, v68
    v_mul_f32 v61, v61, v69
    v_mul_f32 v62, v62, v70
    v_mul_f32 v63, v63, v71
    v_cvt_pk_bf16_f32 v84, v60, v61
    v_cvt_pk_bf16_f32 v85, v62, v63
    v_mul_f32 v68, v64, v64
    v_mul_f32 v69, v65, v65
    v_mul_f32 v70, v66, v66
    v_mul_f32 v71, v67, v67
    v_fma_f32 v68, v68, v119, v118
    v_fma_f32 v69, v69, v119, v118
    v_fma_f32 v70, v70, v119, v118
    v_fma_f32 v71, v71, v119, v118
    v_mul_f32 v68, v68, v64
    v_mul_f32 v69, v69, v65
    v_mul_f32 v70, v70, v66
    v_mul_f32 v71, v71, v67
    v_exp_f32 v68, v68
    v_exp_f32 v69, v69
    v_exp_f32 v70, v70
    v_exp_f32 v71, v71
    v_fma_f32 v68, v68, v117, v117
    v_fma_f32 v69, v69, v117, v117
    v_fma_f32 v70, v70, v117, v117
    v_fma_f32 v71, v71, v117, v117
    v_rcp_f32 v68, v68
    v_rcp_f32 v69, v69
    v_rcp_f32 v70, v70
    v_rcp_f32 v71, v71
    v_mul_f32 v64, v64, v68
    v_mul_f32 v65, v65, v69
    v_mul_f32 v66, v66, v70
    v_mul_f32 v67, v67, v71
    v_cvt_pk_bf16_f32 v86, v64, v65
    v_cvt_pk_bf16_f32 v87, v66, v67
    buffer_store_dwordx4 v[80:83], v120, s[12:15], s85 offen offset:2048 sc1
    buffer_store_dwordx4 v[84:87], v120, s[12:15], s85 offen offset:3072 sc1
L_pa_b_midb:
    s_load_dwordx2 s[36:37], s[0:1], 16
    s_load_dwordx2 s[38:39], s[0:1], 56
    s_lshl_b32 s34, s25, 2
    s_add_u32 s34, s34, s26
    s_sub_u32 s34, s34, 28
    s_mov_b32 s54, 917504
    v_lshrrev_b32 v2, 2, v1
    v_and_b32 v3, 3, v1
    v_lshlrev_b32 v3, 4, v3
    v_lshl_add_u32 v2, v2, 10, v3
    s_waitcnt lgkmcnt(0)
    s_cmp_lt_u32 s34, 16
    s_cselect_b32 s52, s36, s38
    s_cselect_b32 s53, s37, s39
    s_cselect_b32 s54, 524288, s54
    s_cselect_b32 s35, 8, 14
    s_cselect_b32 s67, 0, 32768
    s_mov_b32 s55, 0x20000
    s_and_b32 s34, s34, 15
    s_mul_i32 s68, s24, s35
    s_lshl_b32 s69, s68, 14
    s_lshl_b32 s60, s34, 6
    s_add_u32 s69, s69, s60
    s_mul_i32 s60, s34, 90112
    s_lshl_b32 s68, s68, 10
    s_add_u32 s60, s60, s68
    s_add_u32 s60, s60, s67
    s_add_u32 s60, s60, 20971520
    s_lshl_b32 s61, s24, 13
    s_add_u32 s61, s61, 131072
    v_mov_b32 v5, s11
    s_waitcnt vmcnt(0)
    buffer_store_dword v5, off, s[12:15], s89 sc1
    s_sub_u32 s36, s26, 28
    s_lshl_b32 s36, s36, 2
    s_add_u32 s36, s36, s24
    v_lshlrev_b32 v5, 12, v1
    s_lshl_b32 s56, s25, 20
    s_and_b32 s37, s36, 3
    s_lshl_b32 s37, s37, 18
    s_add_u32 s56, s56, s37
    s_lshr_b32 s37, s36, 2
    s_lshl_b32 s37, s37, 10
    s_add_u32 s56, s56, s37
    s_add_u32 m0, s61, 0
    s_nop 0
    buffer_load_dwordx4 v2, s[52:55], s69 offen lds
    s_add_u32 s69, s69, 16384
    s_add_u32 m0, s61, 1024
    s_nop 0
    buffer_load_dwordx4 v2, s[52:55], s69 offen lds
    s_add_u32 s69, s69, 16384
    s_add_u32 m0, s61, 2048
    s_nop 0
    buffer_load_dwordx4 v2, s[52:55], s69 offen lds
    s_add_u32 s69, s69, 16384
    s_add_u32 m0, s61, 3072
    s_nop 0
    buffer_load_dwordx4 v2, s[52:55], s69 offen lds
    s_add_u32 s69, s69, 16384
    s_add_u32 m0, s61, 4096
    s_nop 0
    buffer_load_dwordx4 v2, s[52:55], s69 offen lds
    s_add_u32 s69, s69, 16384
    s_add_u32 m0, s61, 5120
    s_nop 0
    buffer_load_dwordx4 v2, s[52:55], s69 offen lds
    s_add_u32 s69, s69, 16384
    s_add_u32 m0, s61, 6144
    s_nop 0
    buffer_load_dwordx4 v2, s[52:55], s69 offen lds
    s_add_u32 s69, s69, 16384
    s_add_u32 m0, s61, 7168
    s_nop 0
    buffer_load_dwordx4 v2, s[52:55], s69 offen lds
    s_add_u32 s69, s69, 16384
    buffer_load_dword v6, v5, s[16:19], s56 offen offset:0
    buffer_load_dword v6, v5, s[16:19], s56 offen offset:128
    buffer_load_dword v6, v5, s[16:19], s56 offen offset:256
    buffer_load_dword v6, v5, s[16:19], s56 offen offset:384
    buffer_load_dword v6, v5, s[16:19], s56 offen offset:512
    buffer_load_dword v6, v5, s[16:19], s56 offen offset:640
    buffer_load_dword v6, v5, s[16:19], s56 offen offset:768
    buffer_load_dword v6, v5, s[16:19], s56 offen offset:896
    v_lshrrev_b32 v4, 5, v1
    v_lshlrev_b32 v3, 9, v4
    v_bfe_u32 v4, v1, 2, 2
    v_lshl_add_u32 v3, v4, 6, v3
    v_bfe_u32 v4, v1, 4, 1
    v_lshl_add_u32 v3, v4, 5, v3
    v_and_b32 v4, 1, v1
    v_lshl_add_u32 v3, v4, 4, v3
    v_bfe_u32 v4, v1, 1, 1
    v_lshl_add_u32 v3, v4, 3, v3
    v_add_u32 v3, s61, v3
    s_waitcnt vmcnt(8)
    ds_read_b64_tr_b16 v[8:9], v3 offset:0
    ds_read_b64_tr_b16 v[10:11], v3 offset:256
    ds_read_b64_tr_b16 v[12:13], v3 offset:1024
    ds_read_b64_tr_b16 v[14:15], v3 offset:1280
    ds_read_b64_tr_b16 v[16:17], v3 offset:2048
    ds_read_b64_tr_b16 v[18:19], v3 offset:2304
    ds_read_b64_tr_b16 v[20:21], v3 offset:3072
    ds_read_b64_tr_b16 v[22:23], v3 offset:3328
    s_waitcnt lgkmcnt(0)
    ds_read_b64_tr_b16 v[24:25], v3 offset:4096
    ds_read_b64_tr_b16 v[26:27], v3 offset:4352
    ds_read_b64_tr_b16 v[28:29], v3 offset:5120
    ds_read_b64_tr_b16 v[30:31], v3 offset:5376
    ds_read_b64_tr_b16 v[32:33], v3 offset:6144
    ds_read_b64_tr_b16 v[34:35], v3 offset:6400
    ds_read_b64_tr_b16 v[36:37], v3 offset:7168
    ds_read_b64_tr_b16 v[38:39], v3 offset:7424
    s_waitcnt lgkmcnt(0)
    s_waitcnt lgkmcnt(0)
    buffer_store_dwordx4 v[8:11], v244, s[12:15], s60 offen sc1
    s_add_u32 s60, s60, 1024
    buffer_store_dwordx4 v[12:15], v244, s[12:15], s60 offen sc1
    s_add_u32 s60, s60, 1024
    buffer_store_dwordx4 v[16:19], v244, s[12:15], s60 offen sc1
    s_add_u32 s60, s60, 1024
    buffer_store_dwordx4 v[20:23], v244, s[12:15], s60 offen sc1
    s_add_u32 s60, s60, 1024
    buffer_store_dwordx4 v[24:27], v244, s[12:15], s60 offen sc1
    s_add_u32 s60, s60, 1024
    buffer_store_dwordx4 v[28:31], v244, s[12:15], s60 offen sc1
    s_add_u32 s60, s60, 1024
    buffer_store_dwordx4 v[32:35], v244, s[12:15], s60 offen sc1
    s_add_u32 s60, s60, 1024
    buffer_store_dwordx4 v[36:39], v244, s[12:15], s60 offen sc1
    s_add_u32 s60, s60, 1024
    s_cmp_eq_u32 s35, 8
    s_cbranch_scc1 L_pa_w3done
    s_add_u32 m0, s61, 0
    s_nop 0
    buffer_load_dwordx4 v2, s[52:55], s69 offen lds
    s_add_u32 s69, s69, 16384
    s_add_u32 m0, s61, 1024
    s_nop 0
    buffer_load_dwordx4 v2, s[52:55], s69 offen lds
    s_add_u32 s69, s69, 16384
    s_add_u32 m0, s61, 2048
    s_nop 0
    buffer_load_dwordx4 v2, s[52:55], s69 offen lds
    s_add_u32 s69, s69, 16384
    s_add_u32 m0, s61, 3072
    s_nop 0
    buffer_load_dwordx4 v2, s[52:55], s69 offen lds
    s_add_u32 s69, s69, 16384
    s_add_u32 m0, s61, 4096
    s_nop 0
    buffer_load_dwordx4 v2, s[52:55], s69 offen lds
    s_add_u32 s69, s69, 16384
    s_add_u32 m0, s61, 5120
    s_nop 0
    buffer_load_dwordx4 v2, s[52:55], s69 offen lds
    s_add_u32 s69, s69, 16384
    s_waitcnt vmcnt(0)
    ds_read_b64_tr_b16 v[8:9], v3 offset:0
    ds_read_b64_tr_b16 v[10:11], v3 offset:256
    ds_read_b64_tr_b16 v[12:13], v3 offset:1024
    ds_read_b64_tr_b16 v[14:15], v3 offset:1280
    ds_read_b64_tr_b16 v[16:17], v3 offset:2048
    ds_read_b64_tr_b16 v[18:19], v3 offset:2304
    ds_read_b64_tr_b16 v[20:21], v3 offset:3072
    ds_read_b64_tr_b16 v[22:23], v3 offset:3328
    s_waitcnt lgkmcnt(0)
    ds_read_b64_tr_b16 v[24:25], v3 offset:4096
    ds_read_b64_tr_b16 v[26:27], v3 offset:4352
    ds_read_b64_tr_b16 v[28:29], v3 offset:5120
    ds_read_b64_tr_b16 v[30:31], v3 offset:5376
    s_waitcnt lgkmcnt(0)
    buffer_store_dwordx4 v[8:11], v244, s[12:15], s60 offen sc1
    s_add_u32 s60, s60, 1024
    buffer_store_dwordx4 v[12:15], v244, s[12:15], s60 offen sc1
    s_add_u32 s60, s60, 1024
    buffer_store_dwordx4 v[16:19], v244, s[12:15], s60 offen sc1
    s_add_u32 s60, s60, 1024
    buffer_store_dwordx4 v[20:23], v244, s[12:15], s60 offen sc1
    s_add_u32 s60, s60, 1024
    buffer_store_dwordx4 v[24:27], v244, s[12:15], s60 offen sc1
    s_add_u32 s60, s60, 1024
    buffer_store_dwordx4 v[28:31], v244, s[12:15], s60 offen sc1
    s_add_u32 s60, s60, 1024
L_pa_w3done:
    s_lshr_b32 s33, s34, 1
    s_lshl_b32 s33, s33, 7
    s_and_b32 s34, s34, 1
    s_lshl_b32 s34, s34, 4
    s_add_u32 s33, s33, s34
    s_lshr_b32 s34, s67, 10
    s_add_u32 s33, s33, s34
    s_lshl_b32 s34, s24, 2
    s_add_u32 s33, s33, s34
    s_add_u32 s33, s33, 28323840
    v_mov_b32 v0, s11
    s_waitcnt vmcnt(0)
    buffer_store_dword v0, off, s[12:15], s33 sc1
    s_add_u32 s49, s33, 0xfe4ff000
    s_and_b32 s49, s49, -64
    s_lshr_b32 s48, s26, 3
    s_lshl_b32 s47, s25, 2
    s_add_u32 s48, s48, s47
    s_lshl_b32 s48, s48, 7
    s_lshl_b32 s47, s24, 5
    s_add_u32 s46, s48, s47
    s_mul_i32 s47, s24, 28
    s_add_u32 s48, s48, s47
    s_mov_b32 s48, s49
    s_and_b32 s47, s26, 7
    s_lshl_b32 s47, s47, 7
    s_add_u32 s47, s47, 8192
    v_lshlrev_b32 v237, 2, v1
    v_mov_b32 v238, s48
    v_add_u32 v239, s48, v237
    v_cmp_gt_u32 vcc, 0, v1
    s_nop 1
    v_cndmask_b32 v238, v238, v239, vcc
    v_subrev_u32 v237, 128, v237
    v_add_u32 v239, s47, v237
    v_cmp_gt_u32 vcc, 64, v237
    s_nop 1
    v_cndmask_b32 v238, v238, v239, vcc
    v_subrev_u32 v237, 64, v237
    v_add_u32 v239, s46, v237
    v_cmp_gt_u32 vcc, 0, v237
    s_nop 1
    v_cndmask_b32 v238, v238, v239, vcc
    v_subrev_u32 v237, 32, v237
    v_add_u32 v239, s49, v237
    v_cmp_gt_u32 vcc, 8, v237
    s_nop 1
    v_cndmask_b32 v238, v238, v239, vcc
    s_mov_b32 s48, 28315648
L_pa_g2w:
    s_mov_b32 s48, 28315648
    s_mov_b32 s47, 0
L_pa_p0:
    buffer_load_dword v237, v238, s[12:15], s48 offen sc1
    s_add_u32 s47, s47, 1
    s_waitcnt vmcnt(0)
    v_cmp_ne_u32 vcc, s11, v237
    s_cbranch_vccz L_pa_p0_ok
    s_cmp_gt_u32 s47, 0x10000
    s_cbranch_scc1 L_pa_p0_ok
    s_sleep 32
    s_branch L_pa_p0
L_pa_p0_ok:
    s_setprio 3
    s_load_dwordx2 s[6:7], s[0:1], 0
    s_load_dwordx2 s[8:9], s[0:1], 64
    s_lshr_b32 s27, s26, 3
    s_lshl_b32 s28, s25, 2
    s_add_u32 s27, s27, s28
    s_and_b32 s28, s26, 7
    s_and_b32 s29, s24, 1
    s_lshr_b32 s30, s24, 1
    s_lshl_b32 s32, s27, 1
    s_add_u32 s33, s32, s29
    s_xor_b32 s34, s33, 1
    s_lshl_b32 s32, s28, 1
    s_add_u32 s35, s32, s30
    s_xor_b32 s37, s35, 1
    s_mul_i32 s40, s33, 90112
    s_mul_i32 s41, s34, 90112
    s_mul_i32 s42, s35, 90112
    s_mul_i32 s43, s37, 90112
    s_add_u32 s40, s40, 14680064
    s_add_u32 s41, s41, 14680064
    s_add_u32 s42, s42, 20971520
    s_add_u32 s43, s43, 20971520
    s_mul_i32 s31, s24, 14336
    s_add_u32 s31, s31, 32768
    s_lshl_b32 s32, s24, 13
    s_lshl_b32 s44, s33, 15
    s_lshl_b32 s45, s35, 6
    s_add_u32 s44, s44, s45
    s_mov_b32 s49, 0
    s_waitcnt lgkmcnt(0)
L_pa_g2_redo:
    s_add_u32 s54, s42, s31
    s_add_u32 s54, s54, 0
    buffer_load_dwordx4 v[152:155], v244, s[12:15], s54 offen offset:0 sc1
    s_add_u32 s55, s43, s31
    s_add_u32 s55, s55, 0
    buffer_load_dwordx4 v[156:159], v244, s[12:15], s55 offen offset:0 sc1
    buffer_load_dwordx4 v[160:163], v244, s[12:15], s54 offen offset:1024 sc1
    buffer_load_dwordx4 v[164:167], v244, s[12:15], s55 offen offset:1024 sc1
    buffer_load_dwordx4 v[168:171], v244, s[12:15], s54 offen offset:2048 sc1
    buffer_load_dwordx4 v[172:175], v244, s[12:15], s55 offen offset:2048 sc1
    buffer_load_dwordx4 v[176:179], v244, s[12:15], s54 offen offset:3072 sc1
    buffer_load_dwordx4 v[180:183], v244, s[12:15], s55 offen offset:3072 sc1
    s_add_u32 s54, s42, s31
    s_add_u32 s54, s54, 4096
    buffer_load_dwordx4 v[184:187], v244, s[12:15], s54 offen offset:0 sc1
    s_add_u32 s55, s43, s31
    s_add_u32 s55, s55, 4096
    buffer_load_dwordx4 v[188:191], v244, s[12:15], s55 offen offset:0 sc1
    buffer_load_dwordx4 v[192:195], v244, s[12:15], s54 offen offset:1024 sc1
    buffer_load_dwordx4 v[196:199], v244, s[12:15], s55 offen offset:1024 sc1
    buffer_load_dwordx4 v[200:203], v244, s[12:15], s54 offen offset:2048 sc1
    buffer_load_dwordx4 v[204:207], v244, s[12:15], s55 offen offset:2048 sc1
    buffer_load_dwordx4 v[208:211], v244, s[12:15], s54 offen offset:3072 sc1
    buffer_load_dwordx4 v[212:215], v244, s[12:15], s55 offen offset:3072 sc1
    s_add_u32 s54, s42, s31
    s_add_u32 s54, s54, 8192
    buffer_load_dwordx4 v[216:219], v244, s[12:15], s54 offen offset:0 sc1
    s_add_u32 s55, s43, s31
    s_add_u32 s55, s55, 8192
    buffer_load_dwordx4 v[220:223], v244, s[12:15], s55 offen offset:0 sc1
    buffer_load_dwordx4 v[224:227], v244, s[12:15], s54 offen offset:1024 sc1
    buffer_load_dwordx4 v[228:231], v244, s[12:15], s55 offen offset:1024 sc1
L_pa_g2:
    s_add_u32 s52, s40, s31
    s_add_u32 s53, s41, s31
    s_add_u32 s56, s40, s32
    s_add_u32 s57, s41, s32
    s_add_u32 s58, s42, s32
    s_add_u32 s59, s43, s32
    v_and_b32 v2, 31, v1
    v_lshrrev_b32 v3, 1, v2
    v_xor_b32 v3, v3, v2
    v_and_b32 v3, 4, v3
    v_mul_u32_u24 v3, 3, v3
    v_xor_b32 v2, v2, v3
    v_lshrrev_b32 v3, 5, v1
    v_lshlrev_b32 v3, 4, v3
    v_lshl_add_u32 v245, v2, 10, v3
    s_mov_b32 s16, s6
    s_mov_b32 s17, s7
    s_mov_b32 s18, 0x200000
    s_mov_b32 s19, 0x20000
    s_mov_b32 s20, s8
    s_mov_b32 s21, s9
    s_mov_b32 s22, 0x200000
    s_mov_b32 s23, 0x20000
    s_lshl_b32 s46, s27, 12
    s_mul_i32 s47, s24, 896
    s_add_u32 s46, s46, s47
    s_add_u32 s46, s46, 28442624
    v_min_u32 v248, 6, v1
    v_lshlrev_b32 v248, 7, v248
    s_mov_b32 s47, 0
L_pa_p1:
    buffer_load_dword v250, v248, s[12:15], s46 offen sc1
    s_add_u32 s47, s47, 1
    s_waitcnt vmcnt(0)
    v_cmp_ne_u32 vcc, s11, v250
    s_cbranch_vccz L_pa_p1_ok
    s_cmp_gt_u32 s47, 0x10000
    s_cbranch_scc1 L_pa_p1_ok
    s_sleep 16
    s_branch L_pa_p1
L_pa_p1_ok:
    s_setprio 0
    buffer_load_dwordx4 v[100:103], v244, s[12:15], s52 offen offset:0 sc1
    buffer_load_dwordx4 v[104:107], v244, s[12:15], s53 offen offset:0 sc1
    buffer_load_dwordx4 v[108:111], v244, s[12:15], s52 offen offset:1024 sc1
    buffer_load_dwordx4 v[112:115], v244, s[12:15], s53 offen offset:1024 sc1
    buffer_load_dwordx4 v[116:119], v244, s[12:15], s52 offen offset:2048 sc1
    buffer_load_dwordx4 v[120:123], v244, s[12:15], s53 offen offset:2048 sc1
    buffer_load_dwordx4 v[124:127], v244, s[12:15], s52 offen offset:3072 sc1
    buffer_load_dwordx4 v[128:131], v244, s[12:15], s53 offen offset:3072 sc1
    s_add_u32 s52, s52, 4096
    s_add_u32 s53, s53, 4096
    buffer_load_dwordx4 v[132:135], v244, s[12:15], s52 offen offset:0 sc1
    buffer_load_dwordx4 v[136:139], v244, s[12:15], s53 offen offset:0 sc1
    buffer_load_dwordx4 v[140:143], v244, s[12:15], s52 offen offset:1024 sc1
    buffer_load_dwordx4 v[144:147], v244, s[12:15], s53 offen offset:1024 sc1
    buffer_load_dwordx4 v[148:151], v244, s[12:15], s52 offen offset:2048 sc1
    buffer_load_dwordx4 v[232:235], v244, s[12:15], s53 offen offset:2048 sc1
    buffer_load_dwordx4 v[236:239], v244, s[12:15], s52 offen offset:3072 sc1
    buffer_load_dwordx4 v[240:243], v244, s[12:15], s53 offen offset:3072 sc1
    s_add_u32 s52, s52, 4096
    s_add_u32 s53, s53, 4096
    buffer_load_dwordx4 v[68:71], v244, s[12:15], s52 offen offset:0 sc1
    buffer_load_dwordx4 v[72:75], v244, s[12:15], s53 offen offset:0 sc1
    buffer_load_dwordx4 v[76:79], v244, s[12:15], s52 offen offset:1024 sc1
    buffer_load_dwordx4 v[80:83], v244, s[12:15], s53 offen offset:1024 sc1
    buffer_load_dwordx4 v[84:87], v244, s[12:15], s52 offen offset:2048 sc1
    buffer_load_dwordx4 v[88:91], v244, s[12:15], s53 offen offset:2048 sc1
    buffer_load_dwordx4 v[92:95], v244, s[12:15], s52 offen offset:3072 sc1
    buffer_load_dwordx4 v[96:99], v244, s[12:15], s53 offen offset:3072 sc1
    s_waitcnt vmcnt(22)
    v_mfma_f32_32x32x16_bf16 v[4:19], v[152:155], v[100:103], 0
    v_mfma_f32_32x32x16_bf16 v[20:35], v[152:155], v[104:107], 0
    v_mfma_f32_32x32x16_bf16 v[36:51], v[156:159], v[100:103], 0
    v_mfma_f32_32x32x16_bf16 v[52:67], v[156:159], v[104:107], 0
    s_add_u32 s52, s52, 4096
    s_add_u32 s53, s53, 4096
    buffer_load_dwordx4 v[100:103], v244, s[12:15], s52 offen offset:0 sc1
    buffer_load_dwordx4 v[104:107], v244, s[12:15], s53 offen offset:0 sc1
    s_add_u32 s54, s42, s31
    s_add_u32 s54, s54, 8192
    buffer_load_dwordx4 v[152:155], v244, s[12:15], s54 offen offset:2048 sc1
    s_add_u32 s55, s43, s31
    s_add_u32 s55, s55, 8192
    buffer_load_dwordx4 v[156:159], v244, s[12:15], s55 offen offset:2048 sc1
    s_waitcnt vmcnt(24)
    v_mfma_f32_32x32x16_bf16 v[4:19], v[160:163], v[108:111], v[4:19]
    v_mfma_f32_32x32x16_bf16 v[20:35], v[160:163], v[112:115], v[20:35]
    v_mfma_f32_32x32x16_bf16 v[36:51], v[164:167], v[108:111], v[36:51]
    v_mfma_f32_32x32x16_bf16 v[52:67], v[164:167], v[112:115], v[52:67]
    buffer_load_dwordx4 v[108:111], v244, s[12:15], s52 offen offset:1024 sc1
    buffer_load_dwordx4 v[112:115], v244, s[12:15], s53 offen offset:1024 sc1
    s_add_u32 s54, s42, s31
    s_add_u32 s54, s54, 8192
    buffer_load_dwordx4 v[160:163], v244, s[12:15], s54 offen offset:3072 sc1
    s_add_u32 s55, s43, s31
    s_add_u32 s55, s55, 8192
    buffer_load_dwordx4 v[164:167], v244, s[12:15], s55 offen offset:3072 sc1
    s_waitcnt vmcnt(26)
    v_mfma_f32_32x32x16_bf16 v[4:19], v[168:171], v[116:119], v[4:19]
    v_mfma_f32_32x32x16_bf16 v[20:35], v[168:171], v[120:123], v[20:35]
    v_mfma_f32_32x32x16_bf16 v[36:51], v[172:175], v[116:119], v[36:51]
    v_mfma_f32_32x32x16_bf16 v[52:67], v[172:175], v[120:123], v[52:67]
    s_add_u32 s54, s42, s31
    s_add_u32 s54, s54, 12288
    buffer_load_dwordx4 v[168:171], v244, s[12:15], s54 offen offset:0 sc1
    s_add_u32 s55, s43, s31
    s_add_u32 s55, s55, 12288
    buffer_load_dwordx4 v[172:175], v244, s[12:15], s55 offen offset:0 sc1
    s_waitcnt vmcnt(26)
    v_mfma_f32_32x32x16_bf16 v[4:19], v[176:179], v[124:127], v[4:19]
    v_mfma_f32_32x32x16_bf16 v[20:35], v[176:179], v[128:131], v[20:35]
    v_mfma_f32_32x32x16_bf16 v[36:51], v[180:183], v[124:127], v[36:51]
    v_mfma_f32_32x32x16_bf16 v[52:67], v[180:183], v[128:131], v[52:67]
    s_add_u32 s54, s42, s31
    s_add_u32 s54, s54, 12288
    buffer_load_dwordx4 v[176:179], v244, s[12:15], s54 offen offset:1024 sc1
    s_add_u32 s55, s43, s31
    s_add_u32 s55, s55, 12288
    buffer_load_dwordx4 v[180:183], v244, s[12:15], s55 offen offset:1024 sc1
    s_waitcnt vmcnt(26)
    v_mfma_f32_32x32x16_bf16 v[4:19], v[184:187], v[132:135], v[4:19]
    v_mfma_f32_32x32x16_bf16 v[20:35], v[184:187], v[136:139], v[20:35]
    v_mfma_f32_32x32x16_bf16 v[36:51], v[188:191], v[132:135], v[36:51]
    v_mfma_f32_32x32x16_bf16 v[52:67], v[188:191], v[136:139], v[52:67]
    s_add_u32 s47, s58, 0
    buffer_load_dwordx4 v[184:187], v244, s[12:15], s47 offen offset:0 sc1
    s_add_u32 s47, s59, 0
    buffer_load_dwordx4 v[188:191], v244, s[12:15], s47 offen offset:0 sc1
    s_waitcnt vmcnt(26)
    v_mfma_f32_32x32x16_bf16 v[4:19], v[192:195], v[140:143], v[4:19]
    v_mfma_f32_32x32x16_bf16 v[20:35], v[192:195], v[144:147], v[20:35]
    v_mfma_f32_32x32x16_bf16 v[36:51], v[196:199], v[140:143], v[36:51]
    v_mfma_f32_32x32x16_bf16 v[52:67], v[196:199], v[144:147], v[52:67]
    s_add_u32 s47, s58, 0
    buffer_load_dwordx4 v[192:195], v244, s[12:15], s47 offen offset:1024 sc1
    s_add_u32 s47, s59, 0
    buffer_load_dwordx4 v[196:199], v244, s[12:15], s47 offen offset:1024 sc1
    s_waitcnt vmcnt(26)
    v_mfma_f32_32x32x16_bf16 v[4:19], v[200:203], v[148:151], v[4:19]
    v_mfma_f32_32x32x16_bf16 v[20:35], v[200:203], v[232:235], v[20:35]
    v_mfma_f32_32x32x16_bf16 v[36:51], v[204:207], v[148:151], v[36:51]
    v_mfma_f32_32x32x16_bf16 v[52:67], v[204:207], v[232:235], v[52:67]
    s_add_u32 s47, s58, 0
    buffer_load_dwordx4 v[200:203], v244, s[12:15], s47 offen offset:2048 sc1
    s_add_u32 s47, s59, 0
    buffer_load_dwordx4 v[204:207], v244, s[12:15], s47 offen offset:2048 sc1
    s_waitcnt vmcnt(26)
    v_mfma_f32_32x32x16_bf16 v[4:19], v[208:211], v[236:239], v[4:19]
    v_mfma_f32_32x32x16_bf16 v[20:35], v[208:211], v[240:243], v[20:35]
    v_mfma_f32_32x32x16_bf16 v[36:51], v[212:215], v[236:239], v[36:51]
    v_mfma_f32_32x32x16_bf16 v[52:67], v[212:215], v[240:243], v[52:67]
    s_add_u32 s47, s58, 0
    buffer_load_dwordx4 v[208:211], v244, s[12:15], s47 offen offset:3072 sc1
    s_add_u32 s47, s59, 0
    buffer_load_dwordx4 v[212:215], v244, s[12:15], s47 offen offset:3072 sc1
    s_waitcnt vmcnt(26)
    v_mfma_f32_32x32x16_bf16 v[4:19], v[216:219], v[68:71], v[4:19]
    v_mfma_f32_32x32x16_bf16 v[20:35], v[216:219], v[72:75], v[20:35]
    v_mfma_f32_32x32x16_bf16 v[36:51], v[220:223], v[68:71], v[36:51]
    v_mfma_f32_32x32x16_bf16 v[52:67], v[220:223], v[72:75], v[52:67]
    s_add_u32 s47, s58, 4096
    buffer_load_dwordx4 v[216:219], v244, s[12:15], s47 offen offset:0 sc1
    s_add_u32 s47, s59, 4096
    buffer_load_dwordx4 v[220:223], v244, s[12:15], s47 offen offset:0 sc1
    s_waitcnt vmcnt(26)
    v_mfma_f32_32x32x16_bf16 v[4:19], v[224:227], v[76:79], v[4:19]
    v_mfma_f32_32x32x16_bf16 v[20:35], v[224:227], v[80:83], v[20:35]
    v_mfma_f32_32x32x16_bf16 v[36:51], v[228:231], v[76:79], v[36:51]
    v_mfma_f32_32x32x16_bf16 v[52:67], v[228:231], v[80:83], v[52:67]
    s_add_u32 s47, s58, 4096
    buffer_load_dwordx4 v[224:227], v244, s[12:15], s47 offen offset:1024 sc1
    s_add_u32 s47, s59, 4096
    buffer_load_dwordx4 v[228:231], v244, s[12:15], s47 offen offset:1024 sc1
    s_waitcnt vmcnt(20)
    v_mfma_f32_32x32x16_bf16 v[4:19], v[152:155], v[84:87], v[4:19]
    v_mfma_f32_32x32x16_bf16 v[20:35], v[152:155], v[88:91], v[20:35]
    v_mfma_f32_32x32x16_bf16 v[36:51], v[156:159], v[84:87], v[36:51]
    v_mfma_f32_32x32x16_bf16 v[52:67], v[156:159], v[88:91], v[52:67]
    s_add_u32 s47, s58, 4096
    buffer_load_dwordx4 v[68:71], v244, s[12:15], s47 offen offset:2048 sc1
    s_add_u32 s47, s59, 4096
    buffer_load_dwordx4 v[72:75], v244, s[12:15], s47 offen offset:2048 sc1
    s_waitcnt vmcnt(18)
    v_mfma_f32_32x32x16_bf16 v[4:19], v[160:163], v[92:95], v[4:19]
    v_mfma_f32_32x32x16_bf16 v[20:35], v[160:163], v[96:99], v[20:35]
    v_mfma_f32_32x32x16_bf16 v[36:51], v[164:167], v[92:95], v[36:51]
    v_mfma_f32_32x32x16_bf16 v[52:67], v[164:167], v[96:99], v[52:67]
    s_add_u32 s47, s58, 4096
    buffer_load_dwordx4 v[76:79], v244, s[12:15], s47 offen offset:3072 sc1
    s_add_u32 s47, s59, 4096
    buffer_load_dwordx4 v[80:83], v244, s[12:15], s47 offen offset:3072 sc1
    s_waitcnt vmcnt(18)
    v_mfma_f32_32x32x16_bf16 v[4:19], v[168:171], v[100:103], v[4:19]
    v_mfma_f32_32x32x16_bf16 v[20:35], v[168:171], v[104:107], v[20:35]
    v_mfma_f32_32x32x16_bf16 v[36:51], v[172:175], v[100:103], v[36:51]
    v_mfma_f32_32x32x16_bf16 v[52:67], v[172:175], v[104:107], v[52:67]
    s_waitcnt vmcnt(16)
    v_mfma_f32_32x32x16_bf16 v[4:19], v[176:179], v[108:111], v[4:19]
    v_mfma_f32_32x32x16_bf16 v[20:35], v[176:179], v[112:115], v[20:35]
    v_mfma_f32_32x32x16_bf16 v[36:51], v[180:183], v[108:111], v[36:51]
    v_mfma_f32_32x32x16_bf16 v[52:67], v[180:183], v[112:115], v[52:67]
    buffer_load_dwordx4 v[84:87], v245, s[16:19], s44 offen
    buffer_load_dwordx4 v[88:91], v245, s[16:19], s44 offen offset:32
    s_setprio 3
L_pa_g2_go:
    s_waitcnt vmcnt(0)
    v_and_b32 v167, 0xffff0000, v91
    v_lshlrev_b32 v166, 16, v91
    v_and_b32 v165, 0xffff0000, v90
    v_lshlrev_b32 v164, 16, v90
    v_and_b32 v163, 0xffff0000, v89
    v_lshlrev_b32 v162, 16, v89
    v_and_b32 v161, 0xffff0000, v88
    v_lshlrev_b32 v160, 16, v88
    v_and_b32 v159, 0xffff0000, v87
    v_lshlrev_b32 v158, 16, v87
    v_and_b32 v157, 0xffff0000, v86
    v_lshlrev_b32 v156, 16, v86
    v_and_b32 v155, 0xffff0000, v85
    v_lshlrev_b32 v154, 16, v85
    v_and_b32 v153, 0xffff0000, v84
    v_lshlrev_b32 v152, 16, v84
    s_barrier
    s_add_u32 s58, s56, 4096
    s_add_u32 s59, s57, 4096
    s_mov_b32 s49, 0
L_pa_p3:
    s_lshl_b32 s45, s27, 12
    s_lshl_b32 s47, s24, 10
    s_add_u32 s45, s45, s47
    s_add_u32 s45, s45, 28573696
    v_and_b32 v247, 7, v1
    v_lshlrev_b32 v247, 7, v247
    s_mov_b32 s47, 0
L_pa_p2:
    buffer_load_dword v250, v247, s[12:15], s45 offen sc1
    s_add_u32 s47, s47, 1
    s_waitcnt vmcnt(0)
    v_cmp_ne_u32 vcc, s11, v250
    s_cbranch_vccz L_pa_p2_ok
    s_cmp_gt_u32 s47, 0x10000
    s_cbranch_scc1 L_pa_p2_ok
    s_sleep 8
    s_branch L_pa_p2
L_pa_p2_ok:
L_pa_p3b:
    buffer_load_dwordx4 v[100:103], v244, s[12:15], s56 offen offset:0 sc1
    buffer_load_dwordx4 v[104:107], v244, s[12:15], s57 offen offset:0 sc1
    buffer_load_dwordx4 v[108:111], v244, s[12:15], s56 offen offset:1024 sc1
    buffer_load_dwordx4 v[112:115], v244, s[12:15], s57 offen offset:1024 sc1
    buffer_load_dwordx4 v[116:119], v244, s[12:15], s56 offen offset:2048 sc1
    buffer_load_dwordx4 v[120:123], v244, s[12:15], s57 offen offset:2048 sc1
    buffer_load_dwordx4 v[124:127], v244, s[12:15], s56 offen offset:3072 sc1
    buffer_load_dwordx4 v[128:131], v244, s[12:15], s57 offen offset:3072 sc1
    buffer_load_dwordx4 v[132:135], v244, s[12:15], s58 offen offset:0 sc1
    buffer_load_dwordx4 v[136:139], v244, s[12:15], s59 offen offset:0 sc1
    buffer_load_dwordx4 v[140:143], v244, s[12:15], s58 offen offset:1024 sc1
    buffer_load_dwordx4 v[144:147], v244, s[12:15], s59 offen offset:1024 sc1
    buffer_load_dwordx4 v[148:151], v244, s[12:15], s58 offen offset:2048 sc1
    buffer_load_dwordx4 v[232:235], v244, s[12:15], s59 offen offset:2048 sc1
    buffer_load_dwordx4 v[236:239], v244, s[12:15], s58 offen offset:3072 sc1
    buffer_load_dwordx4 v[240:243], v244, s[12:15], s59 offen offset:3072 sc1
L_pa_p3_ok:
    s_xor_b32 s46, s24, 1
    s_mul_i32 s46, s46, 12288
    s_add_u32 s46, s46, 1024
    v_add_u32 v247, s46, v244
    s_xor_b32 s46, s24, 2
    s_mul_i32 s46, s46, 12288
    s_add_u32 s46, s46, 5120
    v_add_u32 v248, s46, v244
    s_xor_b32 s46, s24, 3
    s_mul_i32 s46, s46, 12288
    s_add_u32 s46, s46, 9216
    v_add_u32 v249, s46, v244
    s_mul_i32 s46, s24, 12288
    s_add_u32 s46, s46, 1024
    v_add_u32 v246, s46, v244
    s_waitcnt vmcnt(14)
    v_mfma_f32_32x32x16_bf16 v[4:19], v[184:187], v[100:103], v[4:19]
    v_mfma_f32_32x32x16_bf16 v[20:35], v[184:187], v[104:107], v[20:35]
    v_mfma_f32_32x32x16_bf16 v[36:51], v[188:191], v[100:103], v[36:51]
    v_mfma_f32_32x32x16_bf16 v[52:67], v[188:191], v[104:107], v[52:67]
    s_waitcnt vmcnt(12)
    v_mfma_f32_32x32x16_bf16 v[4:19], v[192:195], v[108:111], v[4:19]
    v_mfma_f32_32x32x16_bf16 v[20:35], v[192:195], v[112:115], v[20:35]
    v_mfma_f32_32x32x16_bf16 v[36:51], v[196:199], v[108:111], v[36:51]
    v_mfma_f32_32x32x16_bf16 v[52:67], v[196:199], v[112:115], v[52:67]
    s_waitcnt vmcnt(10)
    v_mfma_f32_32x32x16_bf16 v[4:19], v[200:203], v[116:119], v[4:19]
    v_mfma_f32_32x32x16_bf16 v[20:35], v[200:203], v[120:123], v[20:35]
    v_mfma_f32_32x32x16_bf16 v[36:51], v[204:207], v[116:119], v[36:51]
    v_mfma_f32_32x32x16_bf16 v[52:67], v[204:207], v[120:123], v[52:67]
    s_waitcnt vmcnt(8)
    v_mfma_f32_32x32x16_bf16 v[4:19], v[208:211], v[124:127], v[4:19]
    v_mfma_f32_32x32x16_bf16 v[20:35], v[208:211], v[128:131], v[20:35]
    v_mfma_f32_32x32x16_bf16 v[36:51], v[212:215], v[124:127], v[36:51]
    v_mfma_f32_32x32x16_bf16 v[52:67], v[212:215], v[128:131], v[52:67]
    s_waitcnt vmcnt(6)
    v_mfma_f32_32x32x16_bf16 v[4:19], v[216:219], v[132:135], v[4:19]
    v_mfma_f32_32x32x16_bf16 v[20:35], v[216:219], v[136:139], v[20:35]
    v_mfma_f32_32x32x16_bf16 v[36:51], v[220:223], v[132:135], v[36:51]
    v_mfma_f32_32x32x16_bf16 v[52:67], v[220:223], v[136:139], v[52:67]
    s_waitcnt vmcnt(4)
    v_mfma_f32_32x32x16_bf16 v[4:19], v[224:227], v[140:143], v[4:19]
    v_mfma_f32_32x32x16_bf16 v[20:35], v[224:227], v[144:147], v[20:35]
    v_mfma_f32_32x32x16_bf16 v[36:51], v[228:231], v[140:143], v[36:51]
    v_mfma_f32_32x32x16_bf16 v[52:67], v[228:231], v[144:147], v[52:67]
    s_waitcnt vmcnt(2)
    v_mfma_f32_32x32x16_bf16 v[4:19], v[68:71], v[148:151], v[4:19]
    v_mfma_f32_32x32x16_bf16 v[20:35], v[68:71], v[232:235], v[20:35]
    v_mfma_f32_32x32x16_bf16 v[36:51], v[72:75], v[148:151], v[36:51]
    v_mfma_f32_32x32x16_bf16 v[52:67], v[72:75], v[232:235], v[52:67]
    s_waitcnt vmcnt(0)
    v_mfma_f32_32x32x16_bf16 v[20:35], v[76:79], v[240:243], v[20:35]
    v_mfma_f32_32x32x16_bf16 v[36:51], v[80:83], v[236:239], v[36:51]
    v_mfma_f32_32x32x16_bf16 v[52:67], v[80:83], v[240:243], v[52:67]
    v_mfma_f32_32x32x16_bf16 v[4:19], v[76:79], v[236:239], v[4:19]
    s_nop 8
    ds_write_b128 v247, v[20:23] offset:0
    ds_write_b128 v247, v[24:27] offset:1024
    ds_write_b128 v247, v[28:31] offset:2048
    ds_write_b128 v247, v[32:35] offset:3072
    ds_write_b128 v248, v[36:39] offset:0
    ds_write_b128 v248, v[40:43] offset:1024
    ds_write_b128 v248, v[44:47] offset:2048
    ds_write_b128 v248, v[48:51] offset:3072
    ds_write_b128 v249, v[52:55] offset:0
    ds_write_b128 v249, v[56:59] offset:1024
    ds_write_b128 v249, v[60:63] offset:2048
    ds_write_b128 v249, v[64:67] offset:3072
    v_add_f32 v4, v4, v152
    v_add_f32 v5, v5, v153
    v_add_f32 v6, v6, v154
    v_add_f32 v7, v7, v155
    v_add_f32 v8, v8, v156
    v_add_f32 v9, v9, v157
    v_add_f32 v10, v10, v158
    v_add_f32 v11, v11, v159
    v_add_f32 v12, v12, v160
    v_add_f32 v13, v13, v161
    v_add_f32 v14, v14, v162
    v_add_f32 v15, v15, v163
    v_add_f32 v16, v16, v164
    v_add_f32 v17, v17, v165
    v_add_f32 v18, v18, v166
    v_add_f32 v19, v19, v167
    s_waitcnt lgkmcnt(0)
    s_barrier
    ds_read_b128 v[20:23], v246 offset:0
    ds_read_b128 v[24:27], v246 offset:1024
    ds_read_b128 v[28:31], v246 offset:2048
    ds_read_b128 v[32:35], v246 offset:3072
    ds_read_b128 v[36:39], v246 offset:4096
    ds_read_b128 v[40:43], v246 offset:5120
    ds_read_b128 v[44:47], v246 offset:6144
    ds_read_b128 v[48:51], v246 offset:7168
    ds_read_b128 v[52:55], v246 offset:8192
    ds_read_b128 v[56:59], v246 offset:9216
    ds_read_b128 v[60:63], v246 offset:10240
    ds_read_b128 v[64:67], v246 offset:11264
    s_waitcnt lgkmcnt(11)
    v_add_f32 v4, v4, v20
    v_add_f32 v5, v5, v21
    v_add_f32 v6, v6, v22
    v_add_f32 v7, v7, v23
    s_waitcnt lgkmcnt(10)
    v_add_f32 v8, v8, v24
    v_add_f32 v9, v9, v25
    v_add_f32 v10, v10, v26
    v_add_f32 v11, v11, v27
    s_waitcnt lgkmcnt(9)
    v_add_f32 v12, v12, v28
    v_add_f32 v13, v13, v29
    v_add_f32 v14, v14, v30
    v_add_f32 v15, v15, v31
    s_waitcnt lgkmcnt(8)
    v_add_f32 v16, v16, v32
    v_add_f32 v17, v17, v33
    v_add_f32 v18, v18, v34
    v_add_f32 v19, v19, v35
    s_waitcnt lgkmcnt(7)
    v_add_f32 v4, v4, v36
    v_add_f32 v5, v5, v37
    v_add_f32 v6, v6, v38
    v_add_f32 v7, v7, v39
    s_waitcnt lgkmcnt(6)
    v_add_f32 v8, v8, v40
    v_add_f32 v9, v9, v41
    v_add_f32 v10, v10, v42
    v_add_f32 v11, v11, v43
    s_waitcnt lgkmcnt(5)
    v_add_f32 v12, v12, v44
    v_add_f32 v13, v13, v45
    v_add_f32 v14, v14, v46
    v_add_f32 v15, v15, v47
    s_waitcnt lgkmcnt(4)
    v_add_f32 v16, v16, v48
    v_add_f32 v17, v17, v49
    v_add_f32 v18, v18, v50
    v_add_f32 v19, v19, v51
    s_waitcnt lgkmcnt(3)
    v_add_f32 v4, v4, v52
    v_add_f32 v5, v5, v53
    v_add_f32 v6, v6, v54
    v_add_f32 v7, v7, v55
    s_waitcnt lgkmcnt(2)
    v_add_f32 v8, v8, v56
    v_add_f32 v9, v9, v57
    v_add_f32 v10, v10, v58
    v_add_f32 v11, v11, v59
    s_waitcnt lgkmcnt(1)
    v_add_f32 v12, v12, v60
    v_add_f32 v13, v13, v61
    v_add_f32 v14, v14, v62
    v_add_f32 v15, v15, v63
    s_waitcnt lgkmcnt(0)
    v_add_f32 v16, v16, v64
    v_add_f32 v17, v17, v65
    v_add_f32 v18, v18, v66
    v_add_f32 v19, v19, v67
    v_cvt_pk_bf16_f32 v84, v4, v5
    v_cvt_pk_bf16_f32 v85, v6, v7
    v_cvt_pk_bf16_f32 v86, v8, v9
    v_cvt_pk_bf16_f32 v87, v10, v11
    v_cvt_pk_bf16_f32 v88, v12, v13
    v_cvt_pk_bf16_f32 v89, v14, v15
    v_cvt_pk_bf16_f32 v90, v16, v17
    v_cvt_pk_bf16_f32 v91, v18, v19
    buffer_store_dwordx4 v[84:87], v245, s[20:23], s44 offen
    buffer_store_dwordx4 v[88:91], v245, s[20:23], s44 offen offset:32
    s_endpgm
L_pa_retry:
    s_add_u32 s34, s34, 1
    s_cmp_gt_u32 s34, 0x10000
    s_cbranch_scc1 L_pa_chk_ok
    v_and_b32 v2, 31, v1
    v_lshlrev_b32 v2, 4, v2
    v_lshrrev_b32 v3, 5, v1
    v_mul_u32_u24 v3, 3584, v3
    v_add_u32 v2, v2, v3
    buffer_load_dwordx4 v[128:131], v2, s[12:15], s87 offen offset:0 sc1
    buffer_load_dwordx4 v[132:135], v2, s[12:15], s87 offen offset:512 sc1
    buffer_load_dwordx4 v[136:139], v2, s[12:15], s87 offen offset:1024 sc1
    buffer_load_dwordx4 v[140:143], v2, s[12:15], s87 offen offset:1536 sc1
    buffer_load_dwordx4 v[144:147], v2, s[12:15], s87 offen offset:2048 sc1
    buffer_load_dwordx4 v[148:151], v2, s[12:15], s87 offen offset:2560 sc1
    buffer_load_dwordx4 v[152:155], v2, s[12:15], s87 offen offset:3072 sc1
    s_waitcnt vmcnt(0)
    s_branch L_pa_chk
L_pa_g1:
    v_lshrrev_b32 v2, 5, v1
    v_lshlrev_b32 v124, 9, v2
    v_bfe_u32 v3, v1, 2, 2
    v_lshl_add_u32 v124, v3, 6, v124
    v_bfe_u32 v3, v1, 4, 1
    v_lshl_add_u32 v124, v3, 5, v124
    v_and_b32 v3, 1, v1
    v_lshl_add_u32 v124, v3, 4, v124
    v_bfe_u32 v3, v1, 1, 1
    v_lshl_add_u32 v124, v3, 3, v124
    v_add_u32 v124, 67584, v124
    s_mul_i32 s34, s29, 3072
    v_xor_b32 v125, 64, v124
    v_add_u32 v126, s34, v124
    v_add_u32 v127, s34, v125
    v_and_b32 v3, 1, v1
    v_cmp_eq_u32 s[70:71], 1, v3
    v_and_b32 v3, 2, v1
    v_cmp_eq_u32 s[72:73], 2, v3
    s_mul_i32 s87, s32, 262144
    s_mul_i32 s34, s33, 2048
    s_add_u32 s87, s87, s34
    s_add_u32 s87, s87, 2097152
    s_lshr_b32 s34, s32, 1
    s_lshl_b32 s85, s34, 18
    s_lshl_b32 s35, s33, 10
    s_add_u32 s85, s85, s35
    s_mul_i32 s86, s34, 524288
    s_mul_i32 s35, s33, 2048
    s_add_u32 s86, s86, s35
    s_add_u32 s86, s86, 2097152
    s_bitcmp1_b32 s32, 0
    s_cselect_b32 s85, s86, s85
    s_mov_b32 s86, 131072
    s_cselect_b32 s86, s86, 0x10000
    s_mov_b32 s78, 0x3eb8aa3b
    s_cselect_b32 s78, 1.0, s78
    s_lshl_b32 s83, s32, 11
    s_lshl_b32 s34, s31, 7
    s_add_u32 s83, s83, s34
    s_add_u32 s83, s83, 28344320
    s_setprio 1
    s_waitcnt vmcnt(7)
    s_barrier
    ds_read_b128 v[128:131], v112 offset:0
    ds_read_b128 v[132:135], v113 offset:0
    ds_read_b128 v[136:139], v114 offset:0
    ds_read_b128 v[140:143], v115 offset:0
    ds_read_b64_tr_b16 v[68:69], v124 offset:0
    ds_read_b64_tr_b16 v[70:71], v124 offset:256
    ds_read_b64_tr_b16 v[76:77], v124 offset:3072
    ds_read_b64_tr_b16 v[78:79], v124 offset:3328
    s_waitcnt lgkmcnt(2)
    v_mfma_f32_32x32x16_bf16 v[4:19], v[128:131], v[68:71], 0
    ds_read_b64_tr_b16 v[92:93], v126 offset:0
    ds_read_b64_tr_b16 v[94:95], v126 offset:256
    ds_read_b64_tr_b16 v[84:85], v124 offset:6144
    ds_read_b64_tr_b16 v[86:87], v124 offset:6400
    ds_read_b128 v[144:147], v112 offset:4096
    v_mfma_f32_16x16x32_bf16 v[52:55], v[108:111], v[128:131], 0
    v_mfma_f32_4x4x4_16b_bf16 v[56:59], v[128:129], v[128:129], 0
    v_mfma_f32_4x4x4_16b_bf16 v[60:63], v[130:131], v[130:131], 0
    s_add_u32 m0, s58, 114688
    s_add_u32 s69, s80, s66
    s_add_u32 s69, s69, 1792
    buffer_load_dwordx4 v121, s[16:19], s69 offen lds
    s_waitcnt lgkmcnt(3)
    v_mfma_f32_32x32x16_bf16 v[4:19], v[132:135], v[76:79], v[4:19]
    ds_read_b64_tr_b16 v[68:69], v124 offset:9216
    ds_read_b64_tr_b16 v[70:71], v124 offset:9472
    ds_read_b128 v[148:151], v113 offset:4096
    v_mfma_f32_16x16x32_bf16 v[100:103], v[108:111], v[92:95], 0
    v_mfma_f32_16x16x32_bf16 v[52:55], v[108:111], v[132:135], v[52:55]
    v_mfma_f32_4x4x4_16b_bf16 v[56:59], v[132:133], v[132:133], v[56:59]
    v_mfma_f32_4x4x4_16b_bf16 v[60:63], v[134:135], v[134:135], v[60:63]
    s_add_u32 m0, s58, 115712
    s_add_u32 s69, s80, s66
    s_add_u32 s69, s69, 30464
    buffer_load_dwordx4 v121, s[16:19], s69 offen lds
    s_waitcnt lgkmcnt(4)
    v_mfma_f32_32x32x16_bf16 v[4:19], v[136:139], v[84:87], v[4:19]
    ds_read_b64_tr_b16 v[76:77], v124 offset:12288
    ds_read_b64_tr_b16 v[78:79], v124 offset:12544
    ds_read_b128 v[152:155], v114 offset:4096
    v_mfma_f32_16x16x32_bf16 v[52:55], v[108:111], v[136:139], v[52:55]
    v_mfma_f32_4x4x4_16b_bf16 v[56:59], v[136:137], v[136:137], v[56:59]
    v_mfma_f32_4x4x4_16b_bf16 v[60:63], v[138:139], v[138:139], v[60:63]
    s_add_u32 m0, s58, 116736
    s_add_u32 s69, s81, s98
    s_add_u32 s69, s69, 2048
    buffer_load_dwordx4 v122, s[20:23], s69 offen lds
    s_waitcnt lgkmcnt(4)
    v_mfma_f32_32x32x16_bf16 v[4:19], v[140:143], v[68:71], v[4:19]
    ds_read_b64_tr_b16 v[84:85], v124 offset:15360
    ds_read_b64_tr_b16 v[86:87], v124 offset:15616
    ds_read_b128 v[156:159], v115 offset:4096
    v_mfma_f32_16x16x32_bf16 v[52:55], v[108:111], v[140:143], v[52:55]
    v_mfma_f32_4x4x4_16b_bf16 v[56:59], v[140:141], v[140:141], v[56:59]
    v_mfma_f32_4x4x4_16b_bf16 v[60:63], v[142:143], v[142:143], v[60:63]
    s_add_u32 m0, s58, 139264
    s_add_u32 s69, s80, s67
    s_add_u32 s69, s69, 1792
    buffer_load_dwordx4 v121, s[16:19], s69 offen lds
    s_waitcnt lgkmcnt(4)
    v_mfma_f32_32x32x16_bf16 v[4:19], v[144:147], v[76:79], v[4:19]
    ds_read_b64_tr_b16 v[92:93], v126 offset:12288
    ds_read_b64_tr_b16 v[94:95], v126 offset:12544
    ds_read_b64_tr_b16 v[68:69], v124 offset:18432
    ds_read_b64_tr_b16 v[70:71], v124 offset:18688
    v_mfma_f32_16x16x32_bf16 v[52:55], v[108:111], v[144:147], v[52:55]
    v_mfma_f32_4x4x4_16b_bf16 v[56:59], v[144:145], v[144:145], v[56:59]
    v_mfma_f32_4x4x4_16b_bf16 v[60:63], v[146:147], v[146:147], v[60:63]
    s_add_u32 m0, s58, 140288
    s_add_u32 s69, s80, s67
    s_add_u32 s69, s69, 30464
    buffer_load_dwordx4 v121, s[16:19], s69 offen lds
    s_waitcnt lgkmcnt(2)
    v_mfma_f32_32x32x16_bf16 v[4:19], v[148:151], v[84:87], v[4:19]
    ds_read_b64_tr_b16 v[76:77], v124 offset:21504
    ds_read_b64_tr_b16 v[78:79], v124 offset:21760
    v_mfma_f32_16x16x32_bf16 v[100:103], v[108:111], v[92:95], v[100:103]
    v_mfma_f32_16x16x32_bf16 v[52:55], v[108:111], v[148:151], v[52:55]
    v_mfma_f32_4x4x4_16b_bf16 v[56:59], v[148:149], v[148:149], v[56:59]
    v_mfma_f32_4x4x4_16b_bf16 v[60:63], v[150:151], v[150:151], v[60:63]
    s_add_u32 m0, s58, 141312
    s_add_u32 s69, s81, s99
    s_add_u32 s69, s69, 2048
    buffer_load_dwordx4 v122, s[20:23], s69 offen lds
    s_waitcnt lgkmcnt(2)
    v_mfma_f32_32x32x16_bf16 v[4:19], v[152:155], v[68:71], v[4:19]
    s_waitcnt vmcnt(6) lgkmcnt(0)
    s_barrier
    ds_read_b64_tr_b16 v[84:85], v124 offset:24576
    ds_read_b64_tr_b16 v[86:87], v124 offset:24832
    ds_read_b128 v[160:163], v112 offset:8192
    ds_read_b128 v[164:167], v113 offset:8192
    v_mfma_f32_16x16x32_bf16 v[52:55], v[108:111], v[152:155], v[52:55]
    v_mfma_f32_4x4x4_16b_bf16 v[56:59], v[152:153], v[152:153], v[56:59]
    v_mfma_f32_4x4x4_16b_bf16 v[60:63], v[154:155], v[154:155], v[60:63]
    s_add_u32 m0, s59, 0
    s_add_u32 s69, s56, s62
    buffer_load_dwordx4 v116, s[24:27], s69 offen lds
    v_mfma_f32_32x32x16_bf16 v[4:19], v[156:159], v[76:79], v[4:19]
    ds_read_b64_tr_b16 v[68:69], v124 offset:27648
    ds_read_b64_tr_b16 v[70:71], v124 offset:27904
    ds_read_b128 v[168:171], v114 offset:8192
    ds_read_b128 v[172:175], v115 offset:8192
    v_mfma_f32_16x16x32_bf16 v[52:55], v[108:111], v[156:159], v[52:55]
    v_mfma_f32_4x4x4_16b_bf16 v[56:59], v[156:157], v[156:157], v[56:59]
    v_mfma_f32_4x4x4_16b_bf16 v[60:63], v[158:159], v[158:159], v[60:63]
    s_add_u32 m0, s59, 1024
    s_add_u32 s69, s56, s62
    buffer_load_dwordx4 v117, s[24:27], s69 offen lds
    s_waitcnt lgkmcnt(5)
    v_mfma_f32_32x32x16_bf16 v[4:19], v[160:163], v[84:87], v[4:19]
    ds_read_b64_tr_b16 v[92:93], v126 offset:24576
    ds_read_b64_tr_b16 v[94:95], v126 offset:24832
    ds_read_b64_tr_b16 v[76:77], v124 offset:30720
    ds_read_b64_tr_b16 v[78:79], v124 offset:30976
    ds_read_b128 v[176:179], v112 offset:12288
    v_mfma_f32_16x16x32_bf16 v[52:55], v[108:111], v[160:163], v[52:55]
    v_mfma_f32_4x4x4_16b_bf16 v[56:59], v[160:161], v[160:161], v[56:59]
    v_mfma_f32_4x4x4_16b_bf16 v[60:63], v[162:163], v[162:163], v[60:63]
    s_add_u32 m0, s59, 2048
    s_add_u32 s69, s56, s62
    buffer_load_dwordx4 v118, s[24:27], s69 offen lds
    s_waitcnt lgkmcnt(3)
    v_mfma_f32_32x32x16_bf16 v[4:19], v[164:167], v[68:71], v[4:19]
    ds_read_b64_tr_b16 v[84:85], v124 offset:33792
    ds_read_b64_tr_b16 v[86:87], v124 offset:34048
    ds_read_b128 v[180:183], v113 offset:12288
    v_mfma_f32_16x16x32_bf16 v[100:103], v[108:111], v[92:95], v[100:103]
    v_mfma_f32_16x16x32_bf16 v[52:55], v[108:111], v[164:167], v[52:55]
    v_mfma_f32_4x4x4_16b_bf16 v[56:59], v[164:165], v[164:165], v[56:59]
    v_mfma_f32_4x4x4_16b_bf16 v[60:63], v[166:167], v[166:167], v[60:63]
    s_add_u32 m0, s59, 3072
    s_add_u32 s69, s56, s62
    buffer_load_dwordx4 v119, s[24:27], s69 offen lds
    s_waitcnt lgkmcnt(4)
    v_mfma_f32_32x32x16_bf16 v[4:19], v[168:171], v[76:79], v[4:19]
    ds_read_b64_tr_b16 v[68:69], v124 offset:36864
    ds_read_b64_tr_b16 v[70:71], v124 offset:37120
    ds_read_b128 v[184:187], v114 offset:12288
    v_mfma_f32_16x16x32_bf16 v[52:55], v[108:111], v[168:171], v[52:55]
    v_mfma_f32_4x4x4_16b_bf16 v[56:59], v[168:169], v[168:169], v[56:59]
    v_mfma_f32_4x4x4_16b_bf16 v[60:63], v[170:171], v[170:171], v[60:63]
    s_add_u32 m0, s55, 65536
    s_add_u32 s69, s82, s96
    s_add_u32 s69, s69, 0
    buffer_load_dwordx4 v0, s[20:23], s69 offen lds
    s_waitcnt lgkmcnt(4)
    v_mfma_f32_32x32x16_bf16 v[4:19], v[172:175], v[84:87], v[4:19]
    ds_read_b64_tr_b16 v[76:77], v124 offset:39936
    ds_read_b64_tr_b16 v[78:79], v124 offset:40192
    ds_read_b128 v[188:191], v115 offset:12288
    v_mfma_f32_16x16x32_bf16 v[52:55], v[108:111], v[172:175], v[52:55]
    v_mfma_f32_4x4x4_16b_bf16 v[56:59], v[172:173], v[172:173], v[56:59]
    v_mfma_f32_4x4x4_16b_bf16 v[60:63], v[174:175], v[174:175], v[60:63]
    s_add_u32 m0, s55, 66560
    s_add_u32 s69, s82, s96
    s_add_u32 s69, s69, 24576
    buffer_load_dwordx4 v0, s[20:23], s69 offen lds
    s_waitcnt lgkmcnt(4)
    v_mfma_f32_32x32x16_bf16 v[4:19], v[176:179], v[68:71], v[4:19]
    ds_read_b64_tr_b16 v[92:93], v126 offset:36864
    ds_read_b64_tr_b16 v[94:95], v126 offset:37120
    ds_read_b64_tr_b16 v[84:85], v124 offset:43008
    ds_read_b64_tr_b16 v[86:87], v124 offset:43264
    v_mfma_f32_16x16x32_bf16 v[52:55], v[108:111], v[176:179], v[52:55]
    v_mfma_f32_4x4x4_16b_bf16 v[56:59], v[176:177], v[176:177], v[56:59]
    v_mfma_f32_4x4x4_16b_bf16 v[60:63], v[178:179], v[178:179], v[60:63]
    s_waitcnt lgkmcnt(2)
    v_mfma_f32_32x32x16_bf16 v[4:19], v[180:183], v[76:79], v[4:19]
    ds_read_b64_tr_b16 v[68:69], v124 offset:46080
    ds_read_b64_tr_b16 v[70:71], v124 offset:46336
    v_mfma_f32_16x16x32_bf16 v[100:103], v[108:111], v[92:95], v[100:103]
    v_mfma_f32_16x16x32_bf16 v[52:55], v[108:111], v[180:183], v[52:55]
    v_mfma_f32_4x4x4_16b_bf16 v[56:59], v[180:181], v[180:181], v[56:59]
    v_mfma_f32_4x4x4_16b_bf16 v[60:63], v[182:183], v[182:183], v[60:63]
    s_waitcnt lgkmcnt(2)
    v_mfma_f32_32x32x16_bf16 v[4:19], v[184:187], v[84:87], v[4:19]
    s_waitcnt vmcnt(2) lgkmcnt(0)
    s_barrier
    ds_read_b64_tr_b16 v[76:77], v124 offset:49152
    ds_read_b64_tr_b16 v[78:79], v124 offset:49408
    ds_read_b128 v[192:195], v112 offset:0
    ds_read_b128 v[196:199], v113 offset:0
    v_mfma_f32_16x16x32_bf16 v[52:55], v[108:111], v[184:187], v[52:55]
    v_mfma_f32_4x4x4_16b_bf16 v[56:59], v[184:185], v[184:185], v[56:59]
    v_mfma_f32_4x4x4_16b_bf16 v[60:63], v[186:187], v[186:187], v[60:63]
    s_add_u32 m0, s59, 8192
    s_add_u32 s69, s56, s63
    buffer_load_dwordx4 v116, s[24:27], s69 offen lds
    v_mfma_f32_32x32x16_bf16 v[4:19], v[188:191], v[68:71], v[4:19]
    ds_read_b64_tr_b16 v[84:85], v124 offset:52224
    ds_read_b64_tr_b16 v[86:87], v124 offset:52480
    ds_read_b128 v[200:203], v114 offset:0
    ds_read_b128 v[204:207], v115 offset:0
    v_mfma_f32_16x16x32_bf16 v[52:55], v[108:111], v[188:191], v[52:55]
    v_mfma_f32_4x4x4_16b_bf16 v[56:59], v[188:189], v[188:189], v[56:59]
    v_mfma_f32_4x4x4_16b_bf16 v[60:63], v[190:191], v[190:191], v[60:63]
    s_add_u32 m0, s59, 9216
    s_add_u32 s69, s56, s63
    buffer_load_dwordx4 v117, s[24:27], s69 offen lds
    s_waitcnt lgkmcnt(5)
    v_mfma_f32_32x32x16_bf16 v[4:19], v[192:195], v[76:79], v[4:19]
    ds_read_b64_tr_b16 v[92:93], v126 offset:49152
    ds_read_b64_tr_b16 v[94:95], v126 offset:49408
    ds_read_b64_tr_b16 v[68:69], v124 offset:55296
    ds_read_b64_tr_b16 v[70:71], v124 offset:55552
    ds_read_b128 v[208:211], v112 offset:4096
    v_mfma_f32_16x16x32_bf16 v[52:55], v[108:111], v[192:195], v[52:55]
    v_mfma_f32_4x4x4_16b_bf16 v[56:59], v[192:193], v[192:193], v[56:59]
    v_mfma_f32_4x4x4_16b_bf16 v[60:63], v[194:195], v[194:195], v[60:63]
    s_add_u32 m0, s59, 10240
    s_add_u32 s69, s56, s63
    buffer_load_dwordx4 v118, s[24:27], s69 offen lds
    s_waitcnt lgkmcnt(3)
    v_mfma_f32_32x32x16_bf16 v[4:19], v[196:199], v[84:87], v[4:19]
    ds_read_b64_tr_b16 v[76:77], v124 offset:58368
    ds_read_b64_tr_b16 v[78:79], v124 offset:58624
    ds_read_b128 v[212:215], v113 offset:4096
    v_mfma_f32_16x16x32_bf16 v[100:103], v[108:111], v[92:95], v[100:103]
    v_mfma_f32_16x16x32_bf16 v[52:55], v[108:111], v[196:199], v[52:55]
    v_mfma_f32_4x4x4_16b_bf16 v[56:59], v[196:197], v[196:197], v[56:59]
    v_mfma_f32_4x4x4_16b_bf16 v[60:63], v[198:199], v[198:199], v[60:63]
    s_add_u32 m0, s59, 11264
    s_add_u32 s69, s56, s63
    buffer_load_dwordx4 v119, s[24:27], s69 offen lds
    s_waitcnt lgkmcnt(4)
    v_mfma_f32_32x32x16_bf16 v[4:19], v[200:203], v[68:71], v[4:19]
    ds_read_b64_tr_b16 v[84:85], v124 offset:61440
    ds_read_b64_tr_b16 v[86:87], v124 offset:61696
    ds_read_b128 v[216:219], v114 offset:4096
    v_mfma_f32_16x16x32_bf16 v[52:55], v[108:111], v[200:203], v[52:55]
    v_mfma_f32_4x4x4_16b_bf16 v[56:59], v[200:201], v[200:201], v[56:59]
    v_mfma_f32_4x4x4_16b_bf16 v[60:63], v[202:203], v[202:203], v[60:63]
    s_add_u32 m0, s55, 81920
    s_add_u32 s69, s82, s97
    s_add_u32 s69, s69, 0
    buffer_load_dwordx4 v0, s[20:23], s69 offen lds
    s_waitcnt lgkmcnt(4)
    v_mfma_f32_32x32x16_bf16 v[4:19], v[204:207], v[76:79], v[4:19]
    v_add_u32 v124, 0xfc00, v124
    v_add_u32 v125, 0xfc00, v125
    v_add_u32 v126, 0xfc00, v126
    v_add_u32 v127, 0xfc00, v127
    ds_read_b64_tr_b16 v[68:69], v124 offset:0
    ds_read_b64_tr_b16 v[70:71], v124 offset:256
    ds_read_b128 v[220:223], v115 offset:4096
    v_mfma_f32_16x16x32_bf16 v[52:55], v[108:111], v[204:207], v[52:55]
    v_mfma_f32_4x4x4_16b_bf16 v[56:59], v[204:205], v[204:205], v[56:59]
    v_mfma_f32_4x4x4_16b_bf16 v[60:63], v[206:207], v[206:207], v[60:63]
    s_add_u32 m0, s55, 82944
    s_add_u32 s69, s82, s97
    s_add_u32 s69, s69, 24576
    buffer_load_dwordx4 v0, s[20:23], s69 offen lds
    s_waitcnt lgkmcnt(4)
    v_mfma_f32_32x32x16_bf16 v[4:19], v[208:211], v[84:87], v[4:19]
    v_add_u32 v124, 0xfffff400, v124
    v_add_u32 v125, 0xfffff400, v125
    v_add_u32 v126, 0xfffff400, v126
    v_add_u32 v127, 0xfffff400, v127
    ds_read_b64_tr_b16 v[92:93], v126 offset:0
    ds_read_b64_tr_b16 v[94:95], v126 offset:256
    ds_read_b64_tr_b16 v[76:77], v124 offset:6144
    ds_read_b64_tr_b16 v[78:79], v124 offset:6400
    v_mfma_f32_16x16x32_bf16 v[52:55], v[108:111], v[208:211], v[52:55]
    v_mfma_f32_4x4x4_16b_bf16 v[56:59], v[208:209], v[208:209], v[56:59]
    v_mfma_f32_4x4x4_16b_bf16 v[60:63], v[210:211], v[210:211], v[60:63]
    s_add_u32 m0, s55, 98304
    s_add_u32 s69, s82, s98
    s_add_u32 s69, s69, 0
    buffer_load_dwordx4 v0, s[20:23], s69 offen lds
    s_waitcnt lgkmcnt(2)
    v_mfma_f32_32x32x16_bf16 v[4:19], v[212:215], v[68:71], v[4:19]
    ds_read_b64_tr_b16 v[84:85], v124 offset:9216
    ds_read_b64_tr_b16 v[86:87], v124 offset:9472
    v_mfma_f32_16x16x32_bf16 v[100:103], v[108:111], v[92:95], v[100:103]
    v_mfma_f32_16x16x32_bf16 v[52:55], v[108:111], v[212:215], v[52:55]
    v_mfma_f32_4x4x4_16b_bf16 v[56:59], v[212:213], v[212:213], v[56:59]
    v_mfma_f32_4x4x4_16b_bf16 v[60:63], v[214:215], v[214:215], v[60:63]
    s_add_u32 m0, s55, 99328
    s_add_u32 s69, s82, s98
    s_add_u32 s69, s69, 24576
    buffer_load_dwordx4 v0, s[20:23], s69 offen lds
    s_waitcnt lgkmcnt(2)
    v_mfma_f32_32x32x16_bf16 v[4:19], v[216:219], v[76:79], v[4:19]
    s_waitcnt vmcnt(4) lgkmcnt(0)
    s_barrier
    ds_read_b64_tr_b16 v[68:69], v124 offset:12288
    ds_read_b64_tr_b16 v[70:71], v124 offset:12544
    ds_read_b128 v[224:227], v112 offset:8192
    ds_read_b128 v[228:231], v113 offset:8192
    v_mfma_f32_16x16x32_bf16 v[52:55], v[108:111], v[216:219], v[52:55]
    v_mfma_f32_4x4x4_16b_bf16 v[56:59], v[216:217], v[216:217], v[56:59]
    v_mfma_f32_4x4x4_16b_bf16 v[60:63], v[218:219], v[218:219], v[60:63]
    s_add_u32 m0, s55, 114688
    s_add_u32 s69, s82, s99
    s_add_u32 s69, s69, 0
    buffer_load_dwordx4 v0, s[20:23], s69 offen lds
    v_mfma_f32_32x32x16_bf16 v[4:19], v[220:223], v[84:87], v[4:19]
    ds_read_b64_tr_b16 v[76:77], v124 offset:15360
    ds_read_b64_tr_b16 v[78:79], v124 offset:15616
    ds_read_b128 v[232:235], v114 offset:8192
    ds_read_b128 v[236:239], v115 offset:8192
    v_mfma_f32_16x16x32_bf16 v[52:55], v[108:111], v[220:223], v[52:55]
    v_mfma_f32_4x4x4_16b_bf16 v[56:59], v[220:221], v[220:221], v[56:59]
    v_mfma_f32_4x4x4_16b_bf16 v[60:63], v[222:223], v[222:223], v[60:63]
    s_add_u32 m0, s55, 115712
    s_add_u32 s69, s82, s99
    s_add_u32 s69, s69, 24576
    buffer_load_dwordx4 v0, s[20:23], s69 offen lds
    s_waitcnt lgkmcnt(5)
    v_mfma_f32_32x32x16_bf16 v[4:19], v[224:227], v[68:71], v[4:19]
    ds_read_b64_tr_b16 v[92:93], v126 offset:12288
    ds_read_b64_tr_b16 v[94:95], v126 offset:12544
    ds_read_b64_tr_b16 v[84:85], v124 offset:18432
    ds_read_b64_tr_b16 v[86:87], v124 offset:18688
    ds_read_b128 v[240:243], v112 offset:12288
    v_mfma_f32_16x16x32_bf16 v[52:55], v[108:111], v[224:227], v[52:55]
    v_mfma_f32_4x4x4_16b_bf16 v[56:59], v[224:225], v[224:225], v[56:59]
    v_mfma_f32_4x4x4_16b_bf16 v[60:63], v[226:227], v[226:227], v[60:63]
    s_waitcnt lgkmcnt(3)
    v_mfma_f32_32x32x16_bf16 v[4:19], v[228:231], v[76:79], v[4:19]
    ds_read_b64_tr_b16 v[68:69], v124 offset:21504
    ds_read_b64_tr_b16 v[70:71], v124 offset:21760
    ds_read_b128 v[244:247], v113 offset:12288
    v_mfma_f32_16x16x32_bf16 v[100:103], v[108:111], v[92:95], v[100:103]
    v_mfma_f32_16x16x32_bf16 v[52:55], v[108:111], v[228:231], v[52:55]
    v_mfma_f32_4x4x4_16b_bf16 v[56:59], v[228:229], v[228:229], v[56:59]
    v_mfma_f32_4x4x4_16b_bf16 v[60:63], v[230:231], v[230:231], v[60:63]
    s_waitcnt lgkmcnt(4)
    v_mfma_f32_32x32x16_bf16 v[4:19], v[232:235], v[84:87], v[4:19]
    ds_read_b64_tr_b16 v[76:77], v124 offset:24576
    ds_read_b64_tr_b16 v[78:79], v124 offset:24832
    ds_read_b128 v[248:251], v114 offset:12288
    v_mfma_f32_16x16x32_bf16 v[52:55], v[108:111], v[232:235], v[52:55]
    v_mfma_f32_4x4x4_16b_bf16 v[56:59], v[232:233], v[232:233], v[56:59]
    v_mfma_f32_4x4x4_16b_bf16 v[60:63], v[234:235], v[234:235], v[60:63]
    buffer_load_dword v37, off, s[44:47], 0 sc1
    s_waitcnt lgkmcnt(4)
    v_mfma_f32_32x32x16_bf16 v[4:19], v[236:239], v[68:71], v[4:19]
    ds_read_b64_tr_b16 v[84:85], v124 offset:27648
    ds_read_b64_tr_b16 v[86:87], v124 offset:27904
    ds_read_b128 v[252:255], v115 offset:12288
    v_mfma_f32_16x16x32_bf16 v[52:55], v[108:111], v[236:239], v[52:55]
    v_mfma_f32_4x4x4_16b_bf16 v[56:59], v[236:237], v[236:237], v[56:59]
    v_mfma_f32_4x4x4_16b_bf16 v[60:63], v[238:239], v[238:239], v[60:63]
    s_waitcnt lgkmcnt(4)
    v_mfma_f32_32x32x16_bf16 v[4:19], v[240:243], v[76:79], v[4:19]
    ds_read_b64_tr_b16 v[92:93], v126 offset:24576
    ds_read_b64_tr_b16 v[94:95], v126 offset:24832
    ds_read_b64_tr_b16 v[68:69], v124 offset:30720
    ds_read_b64_tr_b16 v[70:71], v124 offset:30976
    v_mfma_f32_16x16x32_bf16 v[52:55], v[108:111], v[240:243], v[52:55]
    v_mfma_f32_4x4x4_16b_bf16 v[56:59], v[240:241], v[240:241], v[56:59]
    v_mfma_f32_4x4x4_16b_bf16 v[60:63], v[242:243], v[242:243], v[60:63]
    s_waitcnt lgkmcnt(2)
    v_mfma_f32_32x32x16_bf16 v[4:19], v[244:247], v[84:87], v[4:19]
    ds_read_b64_tr_b16 v[76:77], v124 offset:33792
    ds_read_b64_tr_b16 v[78:79], v124 offset:34048
    v_mfma_f32_16x16x32_bf16 v[100:103], v[108:111], v[92:95], v[100:103]
    v_mfma_f32_16x16x32_bf16 v[52:55], v[108:111], v[244:247], v[52:55]
    v_mfma_f32_4x4x4_16b_bf16 v[56:59], v[244:245], v[244:245], v[56:59]
    v_mfma_f32_4x4x4_16b_bf16 v[60:63], v[246:247], v[246:247], v[60:63]
    s_waitcnt lgkmcnt(2)
    v_mfma_f32_32x32x16_bf16 v[4:19], v[248:251], v[68:71], v[4:19]
    v_lshl_add_u32 v3, v1, 2, s9
    s_nop 1
    ds_write_b32 v3, v100 offset:768
    v_mfma_f32_16x16x32_bf16 v[52:55], v[108:111], v[248:251], v[52:55]
    v_mfma_f32_4x4x4_16b_bf16 v[56:59], v[248:249], v[248:249], v[56:59]
    v_mfma_f32_4x4x4_16b_bf16 v[60:63], v[250:251], v[250:251], v[60:63]
    s_waitcnt lgkmcnt(1)
    v_mfma_f32_32x32x16_bf16 v[4:19], v[252:255], v[76:79], v[4:19]
    v_mfma_f32_16x16x32_bf16 v[52:55], v[108:111], v[252:255], v[52:55]
    v_mfma_f32_4x4x4_16b_bf16 v[56:59], v[252:253], v[252:253], v[56:59]
    v_mfma_f32_4x4x4_16b_bf16 v[60:63], v[254:255], v[254:255], v[60:63]
    s_nop 4
    v_add_f32 v56, v56, v60
    v_add_f32 v57, v57, v61
    v_add_f32 v58, v58, v62
    v_add_f32 v59, v59, v63
    v_cndmask_b32 v56, v56, v57, s[70:71]
    v_cndmask_b32 v58, v58, v59, s[70:71]
    ds_write_b32 v3, v52 offset:2048
    v_cndmask_b32 v56, v56, v58, s[72:73]
    v_mov_b32 v60, v56
    s_nop 1
    v_permlane32_swap_b32 v56, v60
    v_add_f32 v56, v56, v60
    ds_write_b32 v3, v56 offset:2304
    s_waitcnt vmcnt(0) lgkmcnt(0)
    s_barrier
    v_lshlrev_b32 v2, 2, v1
    ds_read_b32 v68, v2 offset:768
    ds_read_b32 v69, v2 offset:4864
    ds_read_b32 v70, v2 offset:17152
    ds_read_b32 v71, v2 offset:21248
    v_readfirstlane_b32 s11, v37
    s_nop 0
    s_cmp_lg_u32 s11, 0
    s_cbranch_scc1 L_pa_taga
    s_mov_b32 s34, 0
L_pa_tagpa:
    buffer_load_dword v2, off, s[44:47], 0 sc1
    s_add_u32 s34, s34, 1
    s_waitcnt vmcnt(0)
    v_readfirstlane_b32 s11, v2
    s_cmp_gt_u32 s34, 0x10000
    s_cbranch_scc1 L_pa_taga
    s_cmp_eq_u32 s11, 0
    s_cbranch_scc1 L_pa_tagpa
L_pa_taga:
    v_mul_f32 v52, 0x3b000000, v52
    v_cndmask_b32 v53, v52, 0, s[74:75]
    v_mul_f32 v54, v52, v52
    v_cvt_pk_bf16_f32 v112, v53, v53
    v_fma_f32 v56, v56, s76, -v54
    v_and_b32 v55, 0xffff0000, v112
    v_max_f32 v56, 0, v56
    v_sub_f32 v55, v53, v55
    v_add_f32 v56, 0x3727c5ac, v56
    v_cvt_pk_bf16_f32 v113, v55, 0
    v_rsq_f32 v116, v56
    v_mov_b32 v114, 0
    v_mov_b32 v115, 0
    v_lshl_add_u32 v3, v123, 2, s9
    ds_write_b32 v3, v116 offset:2816
    v_lshrrev_b32 v3, 5, v1
    v_lshl_add_u32 v3, v3, 5, s9
    s_waitcnt lgkmcnt(0)
    ds_read_b128 v[20:23], v3 offset:2816
    ds_read_b128 v[24:27], v3 offset:2832
    ds_read_b128 v[28:31], v3 offset:2880
    ds_read_b128 v[32:35], v3 offset:2896
    v_sqrt_f32 v117, v56
    v_mul_f32 v118, 0xc0135761, v116
    v_mul_f32 v119, v116, v116
    v_mul_f32 v119, v119, v118
    v_mul_f32 v119, 0x3d372713, v119
    v_mov_b32 v94, 0
    v_mov_b32 v95, 0
    v_add_f32 v68, v68, v69
    v_add_f32 v70, v70, v71
    v_add_f32 v68, v68, v70
    v_sub_f32 v68, 0, v68
    v_cvt_pk_bf16_f32 v93, v68, 0
    v_lshlrev_b32 v69, 16, v93
    v_sub_f32 v69, v68, v69
    v_cvt_pk_bf16_f32 v92, v68, v69
    s_nop 1
    v_mfma_f32_32x32x16_bf16 v[4:19], v[112:115], v[92:95], v[4:19]
    v_lshrrev_b32 v2, 5, v1
    v_lshlrev_b32 v124, 10, v2
    v_bfe_u32 v3, v1, 2, 2
    v_lshl_add_u32 v124, v3, 7, v124
    v_bfe_u32 v3, v1, 4, 1
    v_lshl_add_u32 v124, v3, 5, v124
    v_and_b32 v3, 1, v1
    v_lshl_add_u32 v124, v3, 4, v124
    v_bfe_u32 v3, v1, 1, 1
    v_lshl_add_u32 v124, v3, 3, v124
    v_bfe_u32 v3, v1, 3, 1
    v_lshl_add_u32 v124, v3, 6, v124
    v_add_u32 v124, 65536, v124
    s_mul_i32 s34, s29, 2048
    v_xor_b32 v125, 64, v124
    v_add_u32 v126, s34, v124
    v_add_u32 v127, s34, v125
    ds_read_b64_tr_b16 v[68:69], v124 offset:0
    ds_read_b64_tr_b16 v[70:71], v124 offset:512
    ds_read_b64_tr_b16 v[72:73], v125 offset:0
    ds_read_b64_tr_b16 v[74:75], v125 offset:512
    ds_read_b64_tr_b16 v[76:77], v124 offset:2048
    ds_read_b64_tr_b16 v[78:79], v124 offset:2560
    ds_read_b64_tr_b16 v[80:81], v125 offset:2048
    ds_read_b64_tr_b16 v[82:83], v125 offset:2560
    s_waitcnt lgkmcnt(4)
    v_mfma_f32_32x32x16_bf16 v[36:51], v[68:71], v[128:131], 0
    ds_read_b64_tr_b16 v[92:93], v126 offset:0
    ds_read_b64_tr_b16 v[94:95], v126 offset:512
    ds_read_b64_tr_b16 v[96:97], v127 offset:0
    ds_read_b64_tr_b16 v[98:99], v127 offset:512
    ds_read_b64_tr_b16 v[84:85], v124 offset:4096
    ds_read_b64_tr_b16 v[86:87], v124 offset:4608
    ds_read_b64_tr_b16 v[88:89], v125 offset:4096
    ds_read_b64_tr_b16 v[90:91], v125 offset:4608
    v_mfma_f32_32x32x16_bf16 v[52:67], v[72:75], v[128:131], 0
    s_add_u32 m0, s55, 131072
    s_add_u32 s69, s80, s64
    s_waitcnt lgkmcnt(4)
    v_mfma_f32_32x32x16_bf16 v[36:51], v[76:79], v[132:135], v[36:51]
    s_add_u32 s69, s69, 0
    buffer_load_dwordx4 v121, s[16:19], s69 offen lds
    ds_read_b64_tr_b16 v[68:69], v124 offset:6144
    ds_read_b64_tr_b16 v[70:71], v124 offset:6656
    ds_read_b64_tr_b16 v[72:73], v125 offset:6144
    ds_read_b64_tr_b16 v[74:75], v125 offset:6656
    v_mfma_f32_32x32x16_bf16 v[52:67], v[80:83], v[132:135], v[52:67]
    s_add_u32 m0, s55, 132096
    s_add_u32 s69, s80, s64
    v_mfma_f32_16x16x32_bf16 v[100:103], v[108:111], v[92:95], 0
    v_mfma_f32_16x16x32_bf16 v[104:107], v[108:111], v[96:99], 0
    s_waitcnt lgkmcnt(4)
    v_mfma_f32_32x32x16_bf16 v[36:51], v[84:87], v[136:139], v[36:51]
    s_add_u32 s69, s69, 28672
    buffer_load_dwordx4 v121, s[16:19], s69 offen lds
    ds_read_b64_tr_b16 v[76:77], v124 offset:8192
    ds_read_b64_tr_b16 v[78:79], v124 offset:8704
    ds_read_b64_tr_b16 v[80:81], v125 offset:8192
    ds_read_b64_tr_b16 v[82:83], v125 offset:8704
    v_mfma_f32_32x32x16_bf16 v[52:67], v[88:91], v[136:139], v[52:67]
    s_add_u32 m0, s55, 147456
    s_add_u32 s69, s80, s65
    s_waitcnt lgkmcnt(4)
    v_mfma_f32_32x32x16_bf16 v[36:51], v[68:71], v[140:143], v[36:51]
    s_add_u32 s69, s69, 0
    buffer_load_dwordx4 v121, s[16:19], s69 offen lds
    ds_read_b64_tr_b16 v[84:85], v124 offset:10240
    ds_read_b64_tr_b16 v[86:87], v124 offset:10752
    ds_read_b64_tr_b16 v[88:89], v125 offset:10240
    ds_read_b64_tr_b16 v[90:91], v125 offset:10752
    v_mfma_f32_32x32x16_bf16 v[52:67], v[72:75], v[140:143], v[52:67]
    s_add_u32 m0, s55, 148480
    s_add_u32 s69, s80, s65
    s_waitcnt lgkmcnt(4)
    v_mfma_f32_32x32x16_bf16 v[36:51], v[76:79], v[144:147], v[36:51]
    s_add_u32 s69, s69, 28672
    buffer_load_dwordx4 v121, s[16:19], s69 offen lds
    ds_read_b64_tr_b16 v[92:93], v126 offset:8192
    ds_read_b64_tr_b16 v[94:95], v126 offset:8704
    ds_read_b64_tr_b16 v[96:97], v127 offset:8192
    ds_read_b64_tr_b16 v[98:99], v127 offset:8704
    ds_read_b64_tr_b16 v[68:69], v124 offset:12288
    ds_read_b64_tr_b16 v[70:71], v124 offset:12800
    ds_read_b64_tr_b16 v[72:73], v125 offset:12288
    ds_read_b64_tr_b16 v[74:75], v125 offset:12800
    v_mfma_f32_32x32x16_bf16 v[52:67], v[80:83], v[144:147], v[52:67]
    s_add_u32 m0, s55, 32768
    s_add_u32 s69, s80, s66
    s_waitcnt lgkmcnt(4)
    v_mfma_f32_32x32x16_bf16 v[36:51], v[84:87], v[148:151], v[36:51]
    s_add_u32 s69, s69, 0
    buffer_load_dwordx4 v121, s[16:19], s69 offen lds
    ds_read_b64_tr_b16 v[76:77], v124 offset:14336
    ds_read_b64_tr_b16 v[78:79], v124 offset:14848
    ds_read_b64_tr_b16 v[80:81], v125 offset:14336
    ds_read_b64_tr_b16 v[82:83], v125 offset:14848
    v_mfma_f32_32x32x16_bf16 v[52:67], v[88:91], v[148:151], v[52:67]
    s_add_u32 m0, s55, 33792
    s_add_u32 s69, s80, s66
    v_mfma_f32_16x16x32_bf16 v[100:103], v[108:111], v[92:95], v[100:103]
    v_mfma_f32_16x16x32_bf16 v[104:107], v[108:111], v[96:99], v[104:107]
    s_waitcnt lgkmcnt(4)
    v_mfma_f32_32x32x16_bf16 v[36:51], v[68:71], v[152:155], v[36:51]
    s_add_u32 s69, s69, 28672
    buffer_load_dwordx4 v121, s[16:19], s69 offen lds
    ds_read_b64_tr_b16 v[84:85], v124 offset:16384
    ds_read_b64_tr_b16 v[86:87], v124 offset:16896
    ds_read_b64_tr_b16 v[88:89], v125 offset:16384
    ds_read_b64_tr_b16 v[90:91], v125 offset:16896
    v_mfma_f32_32x32x16_bf16 v[52:67], v[72:75], v[152:155], v[52:67]
    s_add_u32 m0, s55, 49152
    s_add_u32 s69, s80, s67
    s_waitcnt lgkmcnt(4)
    v_mfma_f32_32x32x16_bf16 v[36:51], v[76:79], v[156:159], v[36:51]
    s_add_u32 s69, s69, 0
    buffer_load_dwordx4 v121, s[16:19], s69 offen lds
    ds_read_b64_tr_b16 v[68:69], v124 offset:18432
    ds_read_b64_tr_b16 v[70:71], v124 offset:18944
    ds_read_b64_tr_b16 v[72:73], v125 offset:18432
    ds_read_b64_tr_b16 v[74:75], v125 offset:18944
    v_mfma_f32_32x32x16_bf16 v[52:67], v[80:83], v[156:159], v[52:67]
    s_add_u32 m0, s55, 50176
    s_add_u32 s69, s80, s67
    s_waitcnt lgkmcnt(4)
    v_mfma_f32_32x32x16_bf16 v[36:51], v[84:87], v[160:163], v[36:51]
    s_add_u32 s69, s69, 28672
    buffer_load_dwordx4 v121, s[16:19], s69 offen lds
    ds_read_b64_tr_b16 v[92:93], v126 offset:16384
    ds_read_b64_tr_b16 v[94:95], v126 offset:16896
    ds_read_b64_tr_b16 v[96:97], v127 offset:16384
    ds_read_b64_tr_b16 v[98:99], v127 offset:16896
    ds_read_b64_tr_b16 v[76:77], v124 offset:20480
    ds_read_b64_tr_b16 v[78:79], v124 offset:20992
    ds_read_b64_tr_b16 v[80:81], v125 offset:20480
    ds_read_b64_tr_b16 v[82:83], v125 offset:20992
    v_mfma_f32_32x32x16_bf16 v[52:67], v[88:91], v[160:163], v[52:67]
    s_mov_b32 s77, 131072
    v_bfe_u32 v3, v1, 4, 1
    s_waitcnt lgkmcnt(4)
    v_mfma_f32_32x32x16_bf16 v[36:51], v[68:71], v[164:167], v[36:51]
    v_mul_lo_u32 v123, v3, s77
    v_and_b32 v3, 15, v1
    ds_read_b64_tr_b16 v[84:85], v124 offset:22528
    ds_read_b64_tr_b16 v[86:87], v124 offset:23040
    ds_read_b64_tr_b16 v[88:89], v125 offset:22528
    ds_read_b64_tr_b16 v[90:91], v125 offset:23040
    v_mfma_f32_32x32x16_bf16 v[52:67], v[72:75], v[164:167], v[52:67]
    v_lshl_add_u32 v123, v3, 4, v123
    v_lshrrev_b32 v3, 5, v1
    v_mfma_f32_16x16x32_bf16 v[100:103], v[108:111], v[92:95], v[100:103]
    v_mfma_f32_16x16x32_bf16 v[104:107], v[108:111], v[96:99], v[104:107]
    s_waitcnt lgkmcnt(4)
    v_mfma_f32_32x32x16_bf16 v[36:51], v[76:79], v[168:171], v[36:51]
    v_lshl_add_u32 v123, v3, 8, v123
    ds_read_b64_tr_b16 v[68:69], v124 offset:24576
    ds_read_b64_tr_b16 v[70:71], v124 offset:25088
    ds_read_b64_tr_b16 v[72:73], v125 offset:24576
    ds_read_b64_tr_b16 v[74:75], v125 offset:25088
    v_mfma_f32_32x32x16_bf16 v[52:67], v[80:83], v[168:171], v[52:67]
    v_mul_f32 v4, v4, v20
    v_mul_f32 v5, v5, v21
    s_waitcnt lgkmcnt(4)
    v_mfma_f32_32x32x16_bf16 v[36:51], v[84:87], v[172:175], v[36:51]
    v_mul_f32 v6, v6, v22
    v_mul_f32 v7, v7, v23
    ds_read_b64_tr_b16 v[76:77], v124 offset:26624
    ds_read_b64_tr_b16 v[78:79], v124 offset:27136
    ds_read_b64_tr_b16 v[80:81], v125 offset:26624
    ds_read_b64_tr_b16 v[82:83], v125 offset:27136
    v_mfma_f32_32x32x16_bf16 v[52:67], v[88:91], v[172:175], v[52:67]
    v_mul_f32 v8, v8, v24
    v_mul_f32 v9, v9, v25
    s_waitcnt lgkmcnt(4)
    v_mfma_f32_32x32x16_bf16 v[36:51], v[68:71], v[176:179], v[36:51]
    v_mul_f32 v10, v10, v26
    v_mul_f32 v11, v11, v27
    ds_read_b64_tr_b16 v[92:93], v126 offset:24576
    ds_read_b64_tr_b16 v[94:95], v126 offset:25088
    ds_read_b64_tr_b16 v[96:97], v127 offset:24576
    ds_read_b64_tr_b16 v[98:99], v127 offset:25088
    ds_read_b64_tr_b16 v[84:85], v124 offset:28672
    ds_read_b64_tr_b16 v[86:87], v124 offset:29184
    ds_read_b64_tr_b16 v[88:89], v125 offset:28672
    ds_read_b64_tr_b16 v[90:91], v125 offset:29184
    v_mfma_f32_32x32x16_bf16 v[52:67], v[72:75], v[176:179], v[52:67]
    v_mul_f32 v12, v12, v28
    v_mul_f32 v13, v13, v29
    s_waitcnt lgkmcnt(4)
    v_mfma_f32_32x32x16_bf16 v[36:51], v[76:79], v[180:183], v[36:51]
    v_mul_f32 v14, v14, v30
    v_mul_f32 v15, v15, v31
    ds_read_b64_tr_b16 v[68:69], v124 offset:30720
    ds_read_b64_tr_b16 v[70:71], v124 offset:31232
    ds_read_b64_tr_b16 v[72:73], v125 offset:30720
    ds_read_b64_tr_b16 v[74:75], v125 offset:31232
    v_mfma_f32_32x32x16_bf16 v[52:67], v[80:83], v[180:183], v[52:67]
    v_mul_f32 v16, v16, v32
    v_mul_f32 v17, v17, v33
    v_mfma_f32_16x16x32_bf16 v[100:103], v[108:111], v[92:95], v[100:103]
    v_mfma_f32_16x16x32_bf16 v[104:107], v[108:111], v[96:99], v[104:107]
    s_waitcnt lgkmcnt(4)
    v_mfma_f32_32x32x16_bf16 v[36:51], v[84:87], v[184:187], v[36:51]
    v_mul_f32 v18, v18, v34
    v_mul_f32 v19, v19, v35
    ds_read_b64_tr_b16 v[76:77], v124 offset:32768
    ds_read_b64_tr_b16 v[78:79], v124 offset:33280
    ds_read_b64_tr_b16 v[80:81], v125 offset:32768
    ds_read_b64_tr_b16 v[82:83], v125 offset:33280
    v_mfma_f32_32x32x16_bf16 v[52:67], v[88:91], v[184:187], v[52:67]
    v_cvt_pk_bf16_f32 v4, v4, v5
    v_cvt_pk_bf16_f32 v5, v6, v7
    s_waitcnt lgkmcnt(4)
    v_mfma_f32_32x32x16_bf16 v[36:51], v[68:71], v[188:191], v[36:51]
    v_cvt_pk_bf16_f32 v6, v8, v9
    v_cvt_pk_bf16_f32 v7, v10, v11
    ds_read_b64_tr_b16 v[84:85], v124 offset:34816
    ds_read_b64_tr_b16 v[86:87], v124 offset:35328
    ds_read_b64_tr_b16 v[88:89], v125 offset:34816
    ds_read_b64_tr_b16 v[90:91], v125 offset:35328
    v_mfma_f32_32x32x16_bf16 v[52:67], v[72:75], v[188:191], v[52:67]
    v_cvt_pk_bf16_f32 v8, v12, v13
    v_cvt_pk_bf16_f32 v9, v14, v15
    s_waitcnt lgkmcnt(4)
    v_mfma_f32_32x32x16_bf16 v[36:51], v[76:79], v[192:195], v[36:51]
    v_cvt_pk_bf16_f32 v10, v16, v17
    v_cvt_pk_bf16_f32 v11, v18, v19
    ds_read_b64_tr_b16 v[92:93], v126 offset:32768
    ds_read_b64_tr_b16 v[94:95], v126 offset:33280
    ds_read_b64_tr_b16 v[96:97], v127 offset:32768
    ds_read_b64_tr_b16 v[98:99], v127 offset:33280
    ds_read_b64_tr_b16 v[68:69], v124 offset:36864
    ds_read_b64_tr_b16 v[70:71], v124 offset:37376
    ds_read_b64_tr_b16 v[72:73], v125 offset:36864
    ds_read_b64_tr_b16 v[74:75], v125 offset:37376
    v_mfma_f32_32x32x16_bf16 v[52:67], v[80:83], v[192:195], v[52:67]
    v_mul_f32 v116, s78, v116
    s_waitcnt vmcnt(0)
    s_waitcnt lgkmcnt(4)
    v_mfma_f32_32x32x16_bf16 v[36:51], v[84:87], v[196:199], v[36:51]
    buffer_store_dwordx4 v[4:7], v123, s[12:15], s87 offen offset:1024 sc1
    buffer_store_dwordx4 v[8:11], v123, s[12:15], s87 offen offset:1536 sc1
    ds_read_b64_tr_b16 v[76:77], v124 offset:38912
    ds_read_b64_tr_b16 v[78:79], v124 offset:39424
    ds_read_b64_tr_b16 v[80:81], v125 offset:38912
    ds_read_b64_tr_b16 v[82:83], v125 offset:39424
    v_mfma_f32_32x32x16_bf16 v[52:67], v[88:91], v[196:199], v[52:67]
    v_mfma_f32_16x16x32_bf16 v[100:103], v[108:111], v[92:95], v[100:103]
    v_mfma_f32_16x16x32_bf16 v[104:107], v[108:111], v[96:99], v[104:107]
    s_waitcnt lgkmcnt(4)
    v_mfma_f32_32x32x16_bf16 v[36:51], v[68:71], v[200:203], v[36:51]
    ds_read_b64_tr_b16 v[84:85], v124 offset:40960
    ds_read_b64_tr_b16 v[86:87], v124 offset:41472
    ds_read_b64_tr_b16 v[88:89], v125 offset:40960
    ds_read_b64_tr_b16 v[90:91], v125 offset:41472
    v_mfma_f32_32x32x16_bf16 v[52:67], v[72:75], v[200:203], v[52:67]
    s_waitcnt lgkmcnt(4)
    v_mfma_f32_32x32x16_bf16 v[36:51], v[76:79], v[204:207], v[36:51]
    ds_read_b64_tr_b16 v[68:69], v124 offset:43008
    ds_read_b64_tr_b16 v[70:71], v124 offset:43520
    ds_read_b64_tr_b16 v[72:73], v125 offset:43008
    ds_read_b64_tr_b16 v[74:75], v125 offset:43520
    v_mfma_f32_32x32x16_bf16 v[52:67], v[80:83], v[204:207], v[52:67]
    s_waitcnt lgkmcnt(4)
    v_mfma_f32_32x32x16_bf16 v[36:51], v[84:87], v[208:211], v[36:51]
    ds_read_b64_tr_b16 v[92:93], v126 offset:40960
    ds_read_b64_tr_b16 v[94:95], v126 offset:41472
    ds_read_b64_tr_b16 v[96:97], v127 offset:40960
    ds_read_b64_tr_b16 v[98:99], v127 offset:41472
    ds_read_b64_tr_b16 v[76:77], v124 offset:45056
    ds_read_b64_tr_b16 v[78:79], v124 offset:45568
    ds_read_b64_tr_b16 v[80:81], v125 offset:45056
    ds_read_b64_tr_b16 v[82:83], v125 offset:45568
    v_mfma_f32_32x32x16_bf16 v[52:67], v[88:91], v[208:211], v[52:67]
    s_waitcnt lgkmcnt(4)
    v_mfma_f32_32x32x16_bf16 v[36:51], v[68:71], v[212:215], v[36:51]
    ds_read_b64_tr_b16 v[84:85], v124 offset:47104
    ds_read_b64_tr_b16 v[86:87], v124 offset:47616
    ds_read_b64_tr_b16 v[88:89], v125 offset:47104
    ds_read_b64_tr_b16 v[90:91], v125 offset:47616
    v_mfma_f32_32x32x16_bf16 v[52:67], v[72:75], v[212:215], v[52:67]
    v_mfma_f32_16x16x32_bf16 v[100:103], v[108:111], v[92:95], v[100:103]
    v_mfma_f32_16x16x32_bf16 v[104:107], v[108:111], v[96:99], v[104:107]
    s_waitcnt lgkmcnt(4)
    v_mfma_f32_32x32x16_bf16 v[36:51], v[76:79], v[216:219], v[36:51]
    ds_read_b64_tr_b16 v[68:69], v124 offset:49152
    ds_read_b64_tr_b16 v[70:71], v124 offset:49664
    ds_read_b64_tr_b16 v[72:73], v125 offset:49152
    ds_read_b64_tr_b16 v[74:75], v125 offset:49664
    v_mfma_f32_32x32x16_bf16 v[52:67], v[80:83], v[216:219], v[52:67]
    s_waitcnt lgkmcnt(4)
    v_mfma_f32_32x32x16_bf16 v[36:51], v[84:87], v[220:223], v[36:51]
    ds_read_b64_tr_b16 v[76:77], v124 offset:51200
    ds_read_b64_tr_b16 v[78:79], v124 offset:51712
    ds_read_b64_tr_b16 v[80:81], v125 offset:51200
    ds_read_b64_tr_b16 v[82:83], v125 offset:51712
    v_mfma_f32_32x32x16_bf16 v[52:67], v[88:91], v[220:223], v[52:67]
    s_waitcnt lgkmcnt(4)
    v_mfma_f32_32x32x16_bf16 v[36:51], v[68:71], v[224:227], v[36:51]
    ds_read_b64_tr_b16 v[92:93], v126 offset:49152
    ds_read_b64_tr_b16 v[94:95], v126 offset:49664
    ds_read_b64_tr_b16 v[96:97], v127 offset:49152
    ds_read_b64_tr_b16 v[98:99], v127 offset:49664
    ds_read_b64_tr_b16 v[84:85], v124 offset:53248
    ds_read_b64_tr_b16 v[86:87], v124 offset:53760
    ds_read_b64_tr_b16 v[88:89], v125 offset:53248
    ds_read_b64_tr_b16 v[90:91], v125 offset:53760
    v_mfma_f32_32x32x16_bf16 v[52:67], v[72:75], v[224:227], v[52:67]
    s_waitcnt lgkmcnt(4)
    v_mfma_f32_32x32x16_bf16 v[36:51], v[76:79], v[228:231], v[36:51]
    ds_read_b64_tr_b16 v[68:69], v124 offset:55296
    ds_read_b64_tr_b16 v[70:71], v124 offset:55808
    ds_read_b64_tr_b16 v[72:73], v125 offset:55296
    ds_read_b64_tr_b16 v[74:75], v125 offset:55808
    v_mfma_f32_32x32x16_bf16 v[52:67], v[80:83], v[228:231], v[52:67]
    v_mfma_f32_16x16x32_bf16 v[100:103], v[108:111], v[92:95], v[100:103]
    v_mfma_f32_16x16x32_bf16 v[104:107], v[108:111], v[96:99], v[104:107]
    s_waitcnt lgkmcnt(4)
    v_mfma_f32_32x32x16_bf16 v[36:51], v[84:87], v[232:235], v[36:51]
    ds_read_b64_tr_b16 v[76:77], v124 offset:57344
    ds_read_b64_tr_b16 v[78:79], v124 offset:57856
    ds_read_b64_tr_b16 v[80:81], v125 offset:57344
    ds_read_b64_tr_b16 v[82:83], v125 offset:57856
    v_mfma_f32_32x32x16_bf16 v[52:67], v[88:91], v[232:235], v[52:67]
    s_waitcnt lgkmcnt(4)
    v_mfma_f32_32x32x16_bf16 v[36:51], v[68:71], v[236:239], v[36:51]
    ds_read_b64_tr_b16 v[84:85], v124 offset:59392
    ds_read_b64_tr_b16 v[86:87], v124 offset:59904
    ds_read_b64_tr_b16 v[88:89], v125 offset:59392
    ds_read_b64_tr_b16 v[90:91], v125 offset:59904
    v_mfma_f32_32x32x16_bf16 v[52:67], v[72:75], v[236:239], v[52:67]
    s_waitcnt lgkmcnt(4)
    v_mfma_f32_32x32x16_bf16 v[36:51], v[76:79], v[240:243], v[36:51]
    ds_read_b64_tr_b16 v[92:93], v126 offset:57344
    ds_read_b64_tr_b16 v[94:95], v126 offset:57856
    ds_read_b64_tr_b16 v[96:97], v127 offset:57344
    ds_read_b64_tr_b16 v[98:99], v127 offset:57856
    ds_read_b64_tr_b16 v[68:69], v124 offset:61440
    ds_read_b64_tr_b16 v[70:71], v124 offset:61952
    ds_read_b64_tr_b16 v[72:73], v125 offset:61440
    ds_read_b64_tr_b16 v[74:75], v125 offset:61952
    v_mfma_f32_32x32x16_bf16 v[52:67], v[80:83], v[240:243], v[52:67]
    s_waitcnt lgkmcnt(4)
    v_mfma_f32_32x32x16_bf16 v[36:51], v[84:87], v[244:247], v[36:51]
    ds_read_b64_tr_b16 v[76:77], v124 offset:63488
    ds_read_b64_tr_b16 v[78:79], v124 offset:64000
    ds_read_b64_tr_b16 v[80:81], v125 offset:63488
    ds_read_b64_tr_b16 v[82:83], v125 offset:64000
    v_mfma_f32_32x32x16_bf16 v[52:67], v[88:91], v[244:247], v[52:67]
    v_mfma_f32_16x16x32_bf16 v[100:103], v[108:111], v[92:95], v[100:103]
    v_mfma_f32_16x16x32_bf16 v[104:107], v[108:111], v[96:99], v[104:107]
    s_waitcnt lgkmcnt(4)
    v_mfma_f32_32x32x16_bf16 v[36:51], v[68:71], v[248:251], v[36:51]
    v_mfma_f32_32x32x16_bf16 v[52:67], v[72:75], v[248:251], v[52:67]
    v_lshl_add_u32 v3, v1, 2, s9
    s_nop 2
    ds_write_b32 v3, v100 offset:1536
    ds_write_b32 v3, v104 offset:1792
    s_waitcnt lgkmcnt(2)
    v_mfma_f32_32x32x16_bf16 v[36:51], v[76:79], v[252:255], v[36:51]
    v_mfma_f32_32x32x16_bf16 v[52:67], v[80:83], v[252:255], v[52:67]
    s_waitcnt lgkmcnt(0)
    s_barrier
    s_setprio 2
    v_lshlrev_b32 v2, 2, v1
    ds_read_b32 v68, v2 offset:1536
    ds_read_b32 v69, v2 offset:5632
    ds_read_b32 v70, v2 offset:17920
    ds_read_b32 v71, v2 offset:22016
    ds_read_b32 v72, v2 offset:1792
    ds_read_b32 v73, v2 offset:5888
    ds_read_b32 v74, v2 offset:18176
    ds_read_b32 v75, v2 offset:22272
    v_mov_b32 v94, 0
    v_mov_b32 v95, 0
    s_waitcnt lgkmcnt(0)
    v_add_f32 v68, v68, v69
    v_add_f32 v70, v70, v71
    v_add_f32 v68, v68, v70
    v_sub_f32 v68, 0, v68
    v_cvt_pk_bf16_f32 v93, v68, 0
    v_lshlrev_b32 v69, 16, v93
    v_sub_f32 v69, v68, v69
    v_cvt_pk_bf16_f32 v92, v68, v69
    s_nop 1
    v_mfma_f32_32x32x16_bf16 v[36:51], v[92:95], v[112:115], v[36:51]
    v_add_f32 v72, v72, v73
    v_add_f32 v74, v74, v75
    v_add_f32 v72, v72, v74
    v_sub_f32 v72, 0, v72
    v_cvt_pk_bf16_f32 v93, v72, 0
    v_lshlrev_b32 v73, 16, v93
    v_sub_f32 v73, v72, v73
    v_cvt_pk_bf16_f32 v92, v72, v73
    s_nop 1
    v_mfma_f32_32x32x16_bf16 v[52:67], v[92:95], v[112:115], v[52:67]
    s_nop 0
    v_mul_f32 v36, v36, v116
    v_mul_f32 v37, v37, v116
    v_mul_f32 v38, v38, v116
    v_mul_f32 v39, v39, v116
    v_mul_f32 v40, v40, v116
    v_mul_f32 v41, v41, v116
    v_mul_f32 v42, v42, v116
    v_mul_f32 v43, v43, v116
    v_mul_f32 v44, v44, v116
    v_mul_f32 v45, v45, v116
    v_mul_f32 v46, v46, v116
    v_mul_f32 v47, v47, v116
    v_mul_f32 v48, v48, v116
    v_mul_f32 v49, v49, v116
    v_mul_f32 v50, v50, v116
    v_mul_f32 v51, v51, v116
    v_cvt_pk_bf16_f32 v36, v36, v37
    v_cvt_pk_bf16_f32 v37, v38, v39
    v_cvt_pk_bf16_f32 v38, v40, v41
    v_cvt_pk_bf16_f32 v39, v42, v43
    v_cvt_pk_bf16_f32 v40, v44, v45
    v_cvt_pk_bf16_f32 v41, v46, v47
    v_cvt_pk_bf16_f32 v42, v48, v49
    v_cvt_pk_bf16_f32 v43, v50, v51
    buffer_store_dwordx4 v[36:39], v120, s[12:15], s85 offen sc1
    s_add_u32 s85, s85, s86
    buffer_store_dwordx4 v[40:43], v120, s[12:15], s85 offen sc1
    s_add_u32 s85, s85, s86
    v_mul_f32 v52, v52, v116
    v_mul_f32 v53, v53, v116
    v_mul_f32 v54, v54, v116
    v_mul_f32 v55, v55, v116
    v_mul_f32 v56, v56, v116
    v_mul_f32 v57, v57, v116
    v_mul_f32 v58, v58, v116
    v_mul_f32 v59, v59, v116
    v_mul_f32 v60, v60, v116
    v_mul_f32 v61, v61, v116
    v_mul_f32 v62, v62, v116
    v_mul_f32 v63, v63, v116
    v_mul_f32 v64, v64, v116
    v_mul_f32 v65, v65, v116
    v_mul_f32 v66, v66, v116
    v_mul_f32 v67, v67, v116
    v_cvt_pk_bf16_f32 v52, v52, v53
    v_cvt_pk_bf16_f32 v53, v54, v55
    v_cvt_pk_bf16_f32 v54, v56, v57
    v_cvt_pk_bf16_f32 v55, v58, v59
    v_cvt_pk_bf16_f32 v56, v60, v61
    v_cvt_pk_bf16_f32 v57, v62, v63
    v_cvt_pk_bf16_f32 v58, v64, v65
    v_cvt_pk_bf16_f32 v59, v66, v67
    buffer_store_dwordx4 v[52:55], v120, s[12:15], s85 offen sc1
    s_add_u32 s85, s85, s86
    buffer_store_dwordx4 v[56:59], v120, s[12:15], s85 offen sc1
    s_add_u32 s85, s85, s86
    s_mov_b32 s24, s10
    s_and_b32 s25, s2, 7
    s_lshr_b32 s26, s2, 3
    s_lshr_b32 s27, s26, 3
    s_lshl_b32 s28, s25, 2
    s_add_u32 s27, s27, s28
    s_and_b32 s28, s26, 7
    s_mul_i32 s30, s27, 131072
    s_add_u32 s30, s30, 2097152
    s_lshl_b32 s31, s27, 16
    s_lshl_b32 s32, s28, 3
    s_lshl_b32 s33, s24, 1
    s_add_u32 s32, s32, s33
    s_lshl_b32 s33, s32, 10
    s_add_u32 s31, s31, s33
    v_lshlrev_b32 v179, 4, v1
    v_mov_b32 v188, 0
    s_lshl_b32 s37, s24, 2
    v_add_u32 v189, s37, v188
    v_mov_b32 v185, 1
    s_waitcnt vmcnt(0)
    ds_write_b32 v189, v185 offset:112
    v_and_b32 v184, 31, v1
    v_lshrrev_b32 v185, 5, v1
    v_lshlrev_b32 v185, 8, v185
    v_lshl_add_u32 v185, v184, 4, v185
    v_and_b32 v186, 27, v184
    v_cmp_eq_u32 vcc, 16, v186
    v_mov_b32 v186, 2064
    v_mov_b32 v187, 2048
    v_cndmask_b32 v186, v186, v187, vcc
    v_mov_b32 v187, 0x3f803f80
    v_cndmask_b32 v190, 0, v187, vcc
    v_cmp_gt_u32 vcc, 16, v184
    v_add_u32 v180, 1024, v185
    v_add_u32 v181, 1536, v185
    v_cndmask_b32 v177, v186, v180, vcc
    v_cndmask_b32 v178, v186, v181, vcc
    s_mov_b32 s48, 0xffff
    s_mov_b32 s49, 0xffff
    v_mov_b32 v144, v190
    v_mov_b32 v145, v190
    v_mov_b32 v146, v190
    v_mov_b32 v147, v190
    v_mov_b32 v148, v190
    v_mov_b32 v149, v190
    v_mov_b32 v150, v190
    v_mov_b32 v151, v190
    v_mov_b32 v160, v190
    v_mov_b32 v161, v190
    v_mov_b32 v162, v190
    v_mov_b32 v163, v190
    v_mov_b32 v164, v190
    v_mov_b32 v165, v190
    v_mov_b32 v166, v190
    v_mov_b32 v167, v190
    v_mul_u32_u24 v208, 2080, v1
    v_mov_b32 v200, 0x3f803f80
    v_mov_b32 v204, 0
    v_mov_b32 v201, 0x3f803f80
    v_mov_b32 v205, 0
    v_mov_b32 v202, 0x3f803f80
    v_mov_b32 v206, 0
    v_mov_b32 v203, 0x3f803f80
    v_mov_b32 v207, 0
    s_cmp_lg_u32 s24, 0
    s_cbranch_scc1 L_pa_att_go
L_pa_att_ad:
    ds_read_b128 v[184:187], v188 offset:112
    s_waitcnt lgkmcnt(0)
    v_min_u32 v184, v184, v185
    v_min3_u32 v184, v184, v186, v187
    v_cmp_gt_u32 vcc, 1, v184
    s_cbranch_vccz L_pa_att_ad_ok
    s_sleep 0
    s_branch L_pa_att_ad
L_pa_att_ad_ok:
    v_mov_b32 v184, s11
    buffer_store_dword v184, off, s[12:15], s83 sc1
    s_lshr_b32 s34, s27, 2
    s_lshl_b32 s34, s34, 12
    s_add_u32 s34, s34, 28344320
    v_and_b32 v182, 31, v1
    v_lshlrev_b32 v182, 7, v182
    s_mov_b32 s47, 0
L_pa_att_p:
    buffer_load_dword v184, v182, s[12:15], s34 offen sc1
    s_add_u32 s47, s47, 1
    s_waitcnt vmcnt(0)
    v_cmp_ne_u32 vcc, s11, v184
    s_cbranch_vccz L_pa_att_p_ok
    s_cmp_gt_u32 s47, 0x10000
    s_cbranch_scc1 L_pa_att_p_ok
    s_sleep 4
    s_branch L_pa_att_p
L_pa_att_p_ok:
    v_mov_b32 v184, 1
    ds_write_b32 v188, v184 offset:96
L_pa_att_go:
L_pa_att_gw:
    ds_read_b32 v184, v188 offset:96
    s_waitcnt lgkmcnt(0)
    v_cmp_gt_u32 vcc, 1, v184
    s_cbranch_vccz L_pa_att_gw_ok
    s_sleep 1
    s_branch L_pa_att_gw
L_pa_att_gw_ok:
    buffer_load_dwordx4 v[4:7], v179, s[12:15], s31 offen sc1
    buffer_load_dwordx4 v[8:11], v179, s[12:15], s31 offen offset:1024 sc1
    buffer_load_dwordx4 v[128:131], v179, s[12:15], s30 offen sc1
    buffer_load_dwordx4 v[132:135], v179, s[12:15], s30 offen offset:2048 sc1
    s_mov_b64 exec, s[48:49]
    buffer_load_dwordx4 v[144:147], v180, s[12:15], s30 offen offset:0 sc1
    buffer_load_dwordx4 v[160:163], v181, s[12:15], s30 offen offset:0 sc1
    buffer_load_dwordx4 v[148:151], v180, s[12:15], s30 offen offset:2048 sc1
    buffer_load_dwordx4 v[164:167], v181, s[12:15], s30 offen offset:2048 sc1
    s_mov_b64 exec, -1
    s_lshl_b32 s38, s24, 11
    s_add_u32 s38, s38, s30
    s_mul_i32 s37, s24, 2080
    s_add_u32 m0, s37, 2080
    s_add_u32 s36, s38, 4096
    buffer_load_dwordx4 v179, s[12:15], s36 offen offset:0 sc1 lds
    buffer_load_dwordx4 v179, s[12:15], s36 offen offset:1024 sc1 lds
    s_add_u32 m0, s37, 10400
    s_add_u32 s36, s38, 12288
    buffer_load_dwordx4 v179, s[12:15], s36 offen offset:0 sc1 lds
    buffer_load_dwordx4 v179, s[12:15], s36 offen offset:1024 sc1 lds
    s_add_u32 m0, s37, 18720
    s_add_u32 s36, s38, 20480
    buffer_load_dwordx4 v179, s[12:15], s36 offen offset:0 sc1 lds
    buffer_load_dwordx4 v179, s[12:15], s36 offen offset:1024 sc1 lds
    s_mov_b32 exec_lo, 0xfff
    s_mov_b32 exec_hi, 0x0
    ds_write_b128 v208, v[200:203] offset:4128
    ds_write_b128 v208, v[204:207] offset:4144
    s_mov_b64 exec, -1
    s_setprio 1
    v_mov_b32 v184, 1
    ds_write_b32 v189, v184 offset:176
    v_mov_b32 v176, v179
    v_mov_b32 v48, 0
    v_mov_b32 v49, 0
    v_mov_b32 v50, 0
    v_mov_b32 v51, 0
    v_mov_b32 v52, 0
    v_mov_b32 v53, 0
    v_mov_b32 v54, 0
    v_mov_b32 v55, 0
    v_mov_b32 v56, 0
    v_mov_b32 v57, 0
    v_mov_b32 v58, 0
    v_mov_b32 v59, 0
    v_mov_b32 v60, 0
    v_mov_b32 v61, 0
    v_mov_b32 v62, 0
    v_mov_b32 v63, 0
    v_mov_b32 v64, 0
    v_mov_b32 v65, 0
    v_mov_b32 v66, 0
    v_mov_b32 v67, 0
    v_mov_b32 v68, 0
    v_mov_b32 v69, 0
    v_mov_b32 v70, 0
    v_mov_b32 v71, 0
    v_mov_b32 v72, 0
    v_mov_b32 v73, 0
    v_mov_b32 v74, 0
    v_mov_b32 v75, 0
    v_mov_b32 v76, 0
    v_mov_b32 v77, 0
    v_mov_b32 v78, 0
    v_mov_b32 v79, 0
    v_mov_b32 v124, 0
    v_mov_b32 v125, 0
    v_mov_b32 v172, 0
    v_mov_b32 v173, 0
    v_mov_b32 v174, 0
    v_mov_b32 v175, 0
    s_waitcnt vmcnt(10)
    v_mfma_f32_32x32x16_bf16 v[80:95], v[128:131], v[4:7], 0
    v_mfma_f32_32x32x16_bf16 v[96:111], v[128:131], v[8:11], 0
    v_mfma_f32_32x32x16_bf16 v[16:31], v[132:135], v[4:7], 0
    v_mfma_f32_32x32x16_bf16 v[32:47], v[132:135], v[8:11], 0
    s_nop 8
    v_max3_f32 v182, v80, v81, v82
    v_max_f32 v182, v182, v83
    v_max3_f32 v182, v182, v84, v85
    v_max3_f32 v182, v182, v86, v87
    v_max3_f32 v182, v182, v88, v89
    v_max3_f32 v182, v182, v90, v91
    v_max3_f32 v182, v182, v92, v93
    v_max3_f32 v182, v182, v94, v95
    v_max3_f32 v183, v96, v97, v98
    v_max_f32 v183, v183, v99
    v_max3_f32 v183, v183, v100, v101
    v_max3_f32 v183, v183, v102, v103
    v_max3_f32 v183, v183, v104, v105
    v_max3_f32 v183, v183, v106, v107
    v_max3_f32 v183, v183, v108, v109
    v_max3_f32 v183, v183, v110, v111
    v_max3_f32 v182, v182, v16, v17
    v_max3_f32 v182, v182, v18, v19
    v_max3_f32 v182, v182, v20, v21
    v_max3_f32 v182, v182, v22, v23
    v_max3_f32 v182, v182, v24, v25
    v_max3_f32 v182, v182, v26, v27
    v_max3_f32 v182, v182, v28, v29
    v_max3_f32 v182, v182, v30, v31
    v_max3_f32 v183, v183, v32, v33
    v_max3_f32 v183, v183, v34, v35
    v_max3_f32 v183, v183, v36, v37
    v_max3_f32 v183, v183, v38, v39
    v_max3_f32 v183, v183, v40, v41
    v_max3_f32 v183, v183, v42, v43
    v_max3_f32 v183, v183, v44, v45
    v_max3_f32 v183, v183, v46, v47
    s_mov_b32 s40, 0x42c80000
    v_mov_b32 v184, v182
    v_mov_b32 v185, v183
    s_nop 0
    v_permlane32_swap_b32 v184, v182
    v_permlane32_swap_b32 v185, v183
    v_max_f32 v182, v182, v184
    v_max_f32 v183, v183, v185
    v_add_f32 v182, s40, v182
    v_add_f32 v183, s40, v183
    v_sub_f32 v16, 0, v182
    v_sub_f32 v17, 0, v182
    v_sub_f32 v18, 0, v182
    v_sub_f32 v19, 0, v182
    v_sub_f32 v20, 0, v182
    v_sub_f32 v21, 0, v182
    v_sub_f32 v22, 0, v182
    v_sub_f32 v23, 0, v182
    v_sub_f32 v24, 0, v182
    v_sub_f32 v25, 0, v182
    v_sub_f32 v26, 0, v182
    v_sub_f32 v27, 0, v182
    v_sub_f32 v28, 0, v182
    v_sub_f32 v29, 0, v182
    v_sub_f32 v30, 0, v182
    v_sub_f32 v31, 0, v182
    v_mov_b32 v108, 0
    v_mov_b32 v109, 0
    v_mov_b32 v110, 0
    v_mov_b32 v111, 0
    v_mfma_f32_32x32x16_bf16 v[80:95], v[128:131], v[4:7], v[16:31]
    v_sub_f32 v32, 0, v183
    v_sub_f32 v33, 0, v183
    v_sub_f32 v34, 0, v183
    v_sub_f32 v35, 0, v183
    v_sub_f32 v36, 0, v183
    v_sub_f32 v37, 0, v183
    v_sub_f32 v38, 0, v183
    v_sub_f32 v39, 0, v183
    v_sub_f32 v40, 0, v183
    v_sub_f32 v41, 0, v183
    v_sub_f32 v42, 0, v183
    v_sub_f32 v43, 0, v183
    v_sub_f32 v44, 0, v183
    v_sub_f32 v45, 0, v183
    v_sub_f32 v46, 0, v183
    v_sub_f32 v47, 0, v183
    s_waitcnt vmcnt(0) lgkmcnt(0)
    v_mov_b32 v184, 1
    ds_write_b32 v189, v184
L_pa_att_f1:
    ds_read_b128 v[184:187], v188 offset:0
    s_waitcnt lgkmcnt(0)
    v_min_u32 v184, v184, v185
    v_min3_u32 v184, v184, v186, v187
    v_cmp_gt_u32 vcc, 1, v184
    s_cbranch_vccz L_pa_att_f1_ok
    s_sleep 1
    s_branch L_pa_att_f1
L_pa_att_f1_ok:
    s_mov_b32 s41, 0
.p2align 6
L_pa_att_loop:
    v_exp_f32 v80, v80
    v_cvt_pk_bf16_f32 v126, v108, v109
    v_exp_f32 v81, v81
    v_cvt_pk_bf16_f32 v127, v110, v111
    v_exp_f32 v82, v82
    v_mfma_f32_32x32x16_bf16 v[96:111], v[128:131], v[8:11], v[32:47]
    v_exp_f32 v83, v83
    v_cvt_pk_bf16_f32 v112, v80, v81
    v_exp_f32 v84, v84
    v_exp_f32 v85, v85
    v_cvt_pk_bf16_f32 v113, v82, v83
    v_exp_f32 v86, v86
    v_mfma_f32_32x32x16_bf16 v[64:79], v[172:175], v[124:127], v[64:79]
    ds_read_b128 v[136:139], v176 offset:2080
    ds_read_b128 v[152:155], v177 offset:2080
    ds_read_b128 v[168:171], v178 offset:2080
    ds_read_b128 v[140:143], v176 offset:4160
    ds_read_b128 v[156:159], v177 offset:4160
    ds_read_b128 v[172:175], v178 offset:4160
    v_exp_f32 v87, v87
    v_cvt_pk_bf16_f32 v114, v84, v85
    v_exp_f32 v88, v88
    v_exp_f32 v89, v89
    v_cvt_pk_bf16_f32 v115, v86, v87
    v_exp_f32 v90, v90
    v_exp_f32 v91, v91
    v_cvt_pk_bf16_f32 v116, v88, v89
    v_exp_f32 v92, v92
    v_mfma_f32_32x32x16_bf16 v[48:63], v[144:147], v[112:115], v[48:63]
    v_exp_f32 v93, v93
    v_cvt_pk_bf16_f32 v117, v90, v91
    v_exp_f32 v94, v94
    v_exp_f32 v95, v95
    v_exp_f32 v96, v96
    v_cvt_pk_bf16_f32 v118, v92, v93
    v_exp_f32 v97, v97
    v_cvt_pk_bf16_f32 v119, v94, v95
    v_exp_f32 v98, v98
    v_mfma_f32_32x32x16_bf16 v[80:95], v[132:135], v[4:7], v[16:31]
    v_exp_f32 v99, v99
    v_cvt_pk_bf16_f32 v120, v96, v97
    v_exp_f32 v100, v100
    v_exp_f32 v101, v101
    v_cvt_pk_bf16_f32 v121, v98, v99
    v_exp_f32 v102, v102
    v_mfma_f32_32x32x16_bf16 v[48:63], v[160:163], v[116:119], v[48:63]
    v_exp_f32 v103, v103
    v_cvt_pk_bf16_f32 v122, v100, v101
    v_exp_f32 v104, v104
    v_exp_f32 v105, v105
    v_cvt_pk_bf16_f32 v123, v102, v103
    v_exp_f32 v106, v106
    v_exp_f32 v107, v107
    v_cvt_pk_bf16_f32 v124, v104, v105
    v_exp_f32 v108, v108
    v_mfma_f32_32x32x16_bf16 v[64:79], v[144:147], v[120:123], v[64:79]
    v_exp_f32 v109, v109
    v_cvt_pk_bf16_f32 v125, v106, v107
    v_exp_f32 v110, v110
    v_exp_f32 v111, v111
    v_exp_f32 v80, v80
    v_cvt_pk_bf16_f32 v126, v108, v109
    v_exp_f32 v81, v81
    v_cvt_pk_bf16_f32 v127, v110, v111
    v_exp_f32 v82, v82
    v_mfma_f32_32x32x16_bf16 v[96:111], v[132:135], v[8:11], v[32:47]
    v_exp_f32 v83, v83
    v_cvt_pk_bf16_f32 v112, v80, v81
    v_exp_f32 v84, v84
    v_exp_f32 v85, v85
    v_cvt_pk_bf16_f32 v113, v82, v83
    v_exp_f32 v86, v86
    v_mfma_f32_32x32x16_bf16 v[64:79], v[160:163], v[124:127], v[64:79]
    v_exp_f32 v87, v87
    v_cvt_pk_bf16_f32 v114, v84, v85
    v_exp_f32 v88, v88
    v_exp_f32 v89, v89
    v_cvt_pk_bf16_f32 v115, v86, v87
    v_exp_f32 v90, v90
    v_exp_f32 v91, v91
    v_cvt_pk_bf16_f32 v116, v88, v89
    v_exp_f32 v92, v92
    v_mfma_f32_32x32x16_bf16 v[48:63], v[148:151], v[112:115], v[48:63]
    v_exp_f32 v93, v93
    v_cvt_pk_bf16_f32 v117, v90, v91
    v_exp_f32 v94, v94
    v_exp_f32 v95, v95
    v_exp_f32 v96, v96
    v_cvt_pk_bf16_f32 v118, v92, v93
    s_waitcnt lgkmcnt(0)
    v_exp_f32 v97, v97
    v_cvt_pk_bf16_f32 v119, v94, v95
    v_exp_f32 v98, v98
    v_mfma_f32_32x32x16_bf16 v[80:95], v[136:139], v[4:7], v[16:31]
    v_exp_f32 v99, v99
    v_cvt_pk_bf16_f32 v120, v96, v97
    v_exp_f32 v100, v100
    v_exp_f32 v101, v101
    v_cvt_pk_bf16_f32 v121, v98, v99
    v_exp_f32 v102, v102
    v_mfma_f32_32x32x16_bf16 v[48:63], v[164:167], v[116:119], v[48:63]
    v_exp_f32 v103, v103
    v_cvt_pk_bf16_f32 v122, v100, v101
    v_exp_f32 v104, v104
    v_exp_f32 v105, v105
    v_cvt_pk_bf16_f32 v123, v102, v103
    v_exp_f32 v106, v106
    v_exp_f32 v107, v107
    v_cvt_pk_bf16_f32 v124, v104, v105
    v_exp_f32 v108, v108
    v_mfma_f32_32x32x16_bf16 v[64:79], v[148:151], v[120:123], v[64:79]
    v_exp_f32 v109, v109
    v_cvt_pk_bf16_f32 v125, v106, v107
    v_exp_f32 v110, v110
    v_exp_f32 v111, v111
    v_exp_f32 v80, v80
    v_cvt_pk_bf16_f32 v126, v108, v109
    v_exp_f32 v81, v81
    v_cvt_pk_bf16_f32 v127, v110, v111
    v_exp_f32 v82, v82
    v_mfma_f32_32x32x16_bf16 v[96:111], v[136:139], v[8:11], v[32:47]
    v_exp_f32 v83, v83
    v_cvt_pk_bf16_f32 v112, v80, v81
    v_exp_f32 v84, v84
    v_exp_f32 v85, v85
    v_cvt_pk_bf16_f32 v113, v82, v83
    v_exp_f32 v86, v86
    v_mfma_f32_32x32x16_bf16 v[64:79], v[164:167], v[124:127], v[64:79]
    ds_read_b128 v[128:131], v176 offset:6240
    ds_read_b128 v[144:147], v177 offset:6240
    ds_read_b128 v[160:163], v178 offset:6240
    ds_read_b128 v[132:135], v176 offset:8320
    ds_read_b128 v[148:151], v177 offset:8320
    ds_read_b128 v[164:167], v178 offset:8320
    v_exp_f32 v87, v87
    v_cvt_pk_bf16_f32 v114, v84, v85
    v_exp_f32 v88, v88
    v_exp_f32 v89, v89
    v_cvt_pk_bf16_f32 v115, v86, v87
    v_exp_f32 v90, v90
    v_exp_f32 v91, v91
    v_cvt_pk_bf16_f32 v116, v88, v89
    v_exp_f32 v92, v92
    v_mfma_f32_32x32x16_bf16 v[48:63], v[152:155], v[112:115], v[48:63]
    v_exp_f32 v93, v93
    v_cvt_pk_bf16_f32 v117, v90, v91
    v_exp_f32 v94, v94
    v_exp_f32 v95, v95
    v_exp_f32 v96, v96
    v_cvt_pk_bf16_f32 v118, v92, v93
    v_exp_f32 v97, v97
    v_cvt_pk_bf16_f32 v119, v94, v95
    v_exp_f32 v98, v98
    v_mfma_f32_32x32x16_bf16 v[80:95], v[140:143], v[4:7], v[16:31]
    v_exp_f32 v99, v99
    v_cvt_pk_bf16_f32 v120, v96, v97
    v_exp_f32 v100, v100
    v_exp_f32 v101, v101
    v_cvt_pk_bf16_f32 v121, v98, v99
    v_exp_f32 v102, v102
    v_mfma_f32_32x32x16_bf16 v[48:63], v[168:171], v[116:119], v[48:63]
    v_exp_f32 v103, v103
    v_cvt_pk_bf16_f32 v122, v100, v101
    v_exp_f32 v104, v104
    v_exp_f32 v105, v105
    v_cvt_pk_bf16_f32 v123, v102, v103
    v_exp_f32 v106, v106
    v_exp_f32 v107, v107
    v_cvt_pk_bf16_f32 v124, v104, v105
    v_exp_f32 v108, v108
    v_mfma_f32_32x32x16_bf16 v[64:79], v[152:155], v[120:123], v[64:79]
    v_exp_f32 v109, v109
    v_cvt_pk_bf16_f32 v125, v106, v107
    v_exp_f32 v110, v110
    v_exp_f32 v111, v111
    v_exp_f32 v80, v80
    v_cvt_pk_bf16_f32 v126, v108, v109
    v_exp_f32 v81, v81
    v_cvt_pk_bf16_f32 v127, v110, v111
    v_exp_f32 v82, v82
    v_mfma_f32_32x32x16_bf16 v[96:111], v[140:143], v[8:11], v[32:47]
    v_exp_f32 v83, v83
    v_cvt_pk_bf16_f32 v112, v80, v81
    v_exp_f32 v84, v84
    v_exp_f32 v85, v85
    v_cvt_pk_bf16_f32 v113, v82, v83
    v_exp_f32 v86, v86
    v_mfma_f32_32x32x16_bf16 v[64:79], v[168:171], v[124:127], v[64:79]
    v_exp_f32 v87, v87
    v_cvt_pk_bf16_f32 v114, v84, v85
    v_exp_f32 v88, v88
    v_exp_f32 v89, v89
    v_cvt_pk_bf16_f32 v115, v86, v87
    v_exp_f32 v90, v90
    v_exp_f32 v91, v91
    v_cvt_pk_bf16_f32 v116, v88, v89
    v_exp_f32 v92, v92
    v_mfma_f32_32x32x16_bf16 v[48:63], v[156:159], v[112:115], v[48:63]
    v_exp_f32 v93, v93
    v_cvt_pk_bf16_f32 v117, v90, v91
    v_exp_f32 v94, v94
    v_exp_f32 v95, v95
    v_exp_f32 v96, v96
    v_cvt_pk_bf16_f32 v118, v92, v93
    s_waitcnt lgkmcnt(0)
    v_exp_f32 v97, v97
    v_cvt_pk_bf16_f32 v119, v94, v95
    v_exp_f32 v98, v98
    v_mfma_f32_32x32x16_bf16 v[80:95], v[128:131], v[4:7], v[16:31]
    v_exp_f32 v99, v99
    v_cvt_pk_bf16_f32 v120, v96, v97
    v_exp_f32 v100, v100
    v_exp_f32 v101, v101
    v_cvt_pk_bf16_f32 v121, v98, v99
    v_exp_f32 v102, v102
    v_mfma_f32_32x32x16_bf16 v[48:63], v[172:175], v[116:119], v[48:63]
    v_exp_f32 v103, v103
    v_cvt_pk_bf16_f32 v122, v100, v101
    v_exp_f32 v104, v104
    v_exp_f32 v105, v105
    v_cvt_pk_bf16_f32 v123, v102, v103
    v_exp_f32 v106, v106
    v_exp_f32 v107, v107
    v_cvt_pk_bf16_f32 v124, v104, v105
    v_exp_f32 v108, v108
    v_mfma_f32_32x32x16_bf16 v[64:79], v[156:159], v[120:123], v[64:79]
    v_exp_f32 v109, v109
    v_cvt_pk_bf16_f32 v125, v106, v107
    v_exp_f32 v110, v110
    v_exp_f32 v111, v111
    v_exp_f32 v80, v80
    v_cvt_pk_bf16_f32 v126, v108, v109
    v_exp_f32 v81, v81
    v_cvt_pk_bf16_f32 v127, v110, v111
    v_exp_f32 v82, v82
    v_mfma_f32_32x32x16_bf16 v[96:111], v[128:131], v[8:11], v[32:47]
    v_exp_f32 v83, v83
    v_cvt_pk_bf16_f32 v112, v80, v81
    v_exp_f32 v84, v84
    v_exp_f32 v85, v85
    v_cvt_pk_bf16_f32 v113, v82, v83
    v_exp_f32 v86, v86
    v_mfma_f32_32x32x16_bf16 v[64:79], v[172:175], v[124:127], v[64:79]
    ds_read_b128 v[136:139], v176 offset:10400
    ds_read_b128 v[152:155], v177 offset:10400
    ds_read_b128 v[168:171], v178 offset:10400
    ds_read_b128 v[140:143], v176 offset:12480
    ds_read_b128 v[156:159], v177 offset:12480
    ds_read_b128 v[172:175], v178 offset:12480
    v_exp_f32 v87, v87
    v_cvt_pk_bf16_f32 v114, v84, v85
    v_exp_f32 v88, v88
    v_exp_f32 v89, v89
    v_cvt_pk_bf16_f32 v115, v86, v87
    v_exp_f32 v90, v90
    v_exp_f32 v91, v91
    v_cvt_pk_bf16_f32 v116, v88, v89
    v_exp_f32 v92, v92
    v_mfma_f32_32x32x16_bf16 v[48:63], v[144:147], v[112:115], v[48:63]
    v_exp_f32 v93, v93
    v_cvt_pk_bf16_f32 v117, v90, v91
    v_exp_f32 v94, v94
    v_exp_f32 v95, v95
    v_exp_f32 v96, v96
    v_cvt_pk_bf16_f32 v118, v92, v93
    v_exp_f32 v97, v97
    v_cvt_pk_bf16_f32 v119, v94, v95
    v_exp_f32 v98, v98
    v_mfma_f32_32x32x16_bf16 v[80:95], v[132:135], v[4:7], v[16:31]
    v_exp_f32 v99, v99
    v_cvt_pk_bf16_f32 v120, v96, v97
    v_exp_f32 v100, v100
    v_exp_f32 v101, v101
    v_cvt_pk_bf16_f32 v121, v98, v99
    v_exp_f32 v102, v102
    v_mfma_f32_32x32x16_bf16 v[48:63], v[160:163], v[116:119], v[48:63]
    v_exp_f32 v103, v103
    v_cvt_pk_bf16_f32 v122, v100, v101
    v_exp_f32 v104, v104
    v_exp_f32 v105, v105
    v_cvt_pk_bf16_f32 v123, v102, v103
    v_exp_f32 v106, v106
    v_exp_f32 v107, v107
    v_cvt_pk_bf16_f32 v124, v104, v105
    v_exp_f32 v108, v108
    v_mfma_f32_32x32x16_bf16 v[64:79], v[144:147], v[120:123], v[64:79]
    v_exp_f32 v109, v109
    v_cvt_pk_bf16_f32 v125, v106, v107
    v_exp_f32 v110, v110
    v_exp_f32 v111, v111
    v_exp_f32 v80, v80
    v_cvt_pk_bf16_f32 v126, v108, v109
    v_exp_f32 v81, v81
    v_cvt_pk_bf16_f32 v127, v110, v111
    v_exp_f32 v82, v82
    v_mfma_f32_32x32x16_bf16 v[96:111], v[132:135], v[8:11], v[32:47]
    v_exp_f32 v83, v83
    v_cvt_pk_bf16_f32 v112, v80, v81
    v_exp_f32 v84, v84
    v_exp_f32 v85, v85
    v_cvt_pk_bf16_f32 v113, v82, v83
    v_exp_f32 v86, v86
    v_mfma_f32_32x32x16_bf16 v[64:79], v[160:163], v[124:127], v[64:79]
    v_exp_f32 v87, v87
    v_cvt_pk_bf16_f32 v114, v84, v85
    v_exp_f32 v88, v88
    v_exp_f32 v89, v89
    v_cvt_pk_bf16_f32 v115, v86, v87
    v_exp_f32 v90, v90
    v_exp_f32 v91, v91
    v_cvt_pk_bf16_f32 v116, v88, v89
    v_exp_f32 v92, v92
    v_mfma_f32_32x32x16_bf16 v[48:63], v[148:151], v[112:115], v[48:63]
    v_exp_f32 v93, v93
    v_cvt_pk_bf16_f32 v117, v90, v91
    v_exp_f32 v94, v94
    v_exp_f32 v95, v95
    v_exp_f32 v96, v96
    v_cvt_pk_bf16_f32 v118, v92, v93
    s_waitcnt lgkmcnt(0)
    v_exp_f32 v97, v97
    v_cvt_pk_bf16_f32 v119, v94, v95
    v_exp_f32 v98, v98
    v_mfma_f32_32x32x16_bf16 v[80:95], v[136:139], v[4:7], v[16:31]
    v_exp_f32 v99, v99
    v_cvt_pk_bf16_f32 v120, v96, v97
    v_exp_f32 v100, v100
    v_exp_f32 v101, v101
    v_cvt_pk_bf16_f32 v121, v98, v99
    v_exp_f32 v102, v102
    v_mfma_f32_32x32x16_bf16 v[48:63], v[164:167], v[116:119], v[48:63]
    v_exp_f32 v103, v103
    v_cvt_pk_bf16_f32 v122, v100, v101
    v_exp_f32 v104, v104
    v_exp_f32 v105, v105
    v_cvt_pk_bf16_f32 v123, v102, v103
    v_exp_f32 v106, v106
    v_exp_f32 v107, v107
    v_cvt_pk_bf16_f32 v124, v104, v105
    v_exp_f32 v108, v108
    v_mfma_f32_32x32x16_bf16 v[64:79], v[148:151], v[120:123], v[64:79]
    v_exp_f32 v109, v109
    v_cvt_pk_bf16_f32 v125, v106, v107
    v_exp_f32 v110, v110
    v_exp_f32 v111, v111
    v_exp_f32 v80, v80
    v_cvt_pk_bf16_f32 v126, v108, v109
    v_exp_f32 v81, v81
    v_cvt_pk_bf16_f32 v127, v110, v111
    v_exp_f32 v82, v82
    v_mfma_f32_32x32x16_bf16 v[96:111], v[136:139], v[8:11], v[32:47]
    v_exp_f32 v83, v83
    v_cvt_pk_bf16_f32 v112, v80, v81
    v_exp_f32 v84, v84
    v_exp_f32 v85, v85
    v_cvt_pk_bf16_f32 v113, v82, v83
    v_exp_f32 v86, v86
    v_mfma_f32_32x32x16_bf16 v[64:79], v[164:167], v[124:127], v[64:79]
    ds_read_b128 v[128:131], v176 offset:14560
    ds_read_b128 v[144:147], v177 offset:14560
    ds_read_b128 v[160:163], v178 offset:14560
    ds_read_b128 v[132:135], v176 offset:16640
    ds_read_b128 v[148:151], v177 offset:16640
    ds_read_b128 v[164:167], v178 offset:16640
    v_exp_f32 v87, v87
    v_cvt_pk_bf16_f32 v114, v84, v85
    v_exp_f32 v88, v88
    v_exp_f32 v89, v89
    v_cvt_pk_bf16_f32 v115, v86, v87
    v_exp_f32 v90, v90
    v_exp_f32 v91, v91
    v_cvt_pk_bf16_f32 v116, v88, v89
    v_exp_f32 v92, v92
    v_mfma_f32_32x32x16_bf16 v[48:63], v[152:155], v[112:115], v[48:63]
    v_exp_f32 v93, v93
    v_cvt_pk_bf16_f32 v117, v90, v91
    v_exp_f32 v94, v94
    v_exp_f32 v95, v95
    v_exp_f32 v96, v96
    v_cvt_pk_bf16_f32 v118, v92, v93
    v_exp_f32 v97, v97
    v_cvt_pk_bf16_f32 v119, v94, v95
    v_exp_f32 v98, v98
    v_mfma_f32_32x32x16_bf16 v[80:95], v[140:143], v[4:7], v[16:31]
    v_exp_f32 v99, v99
    v_cvt_pk_bf16_f32 v120, v96, v97
    v_exp_f32 v100, v100
    v_exp_f32 v101, v101
    v_cvt_pk_bf16_f32 v121, v98, v99
    v_exp_f32 v102, v102
    v_mfma_f32_32x32x16_bf16 v[48:63], v[168:171], v[116:119], v[48:63]
    v_exp_f32 v103, v103
    v_cvt_pk_bf16_f32 v122, v100, v101
    v_exp_f32 v104, v104
    v_exp_f32 v105, v105
    v_cvt_pk_bf16_f32 v123, v102, v103
    v_exp_f32 v106, v106
    v_exp_f32 v107, v107
    v_cvt_pk_bf16_f32 v124, v104, v105
    v_exp_f32 v108, v108
    v_mfma_f32_32x32x16_bf16 v[64:79], v[152:155], v[120:123], v[64:79]
    v_exp_f32 v109, v109
    v_cvt_pk_bf16_f32 v125, v106, v107
    v_exp_f32 v110, v110
    v_exp_f32 v111, v111
    v_exp_f32 v80, v80
    v_cvt_pk_bf16_f32 v126, v108, v109
    v_exp_f32 v81, v81
    v_cvt_pk_bf16_f32 v127, v110, v111
    v_exp_f32 v82, v82
    v_mfma_f32_32x32x16_bf16 v[96:111], v[140:143], v[8:11], v[32:47]
    v_exp_f32 v83, v83
    v_cvt_pk_bf16_f32 v112, v80, v81
    v_exp_f32 v84, v84
    v_exp_f32 v85, v85
    v_cvt_pk_bf16_f32 v113, v82, v83
    v_exp_f32 v86, v86
    v_mfma_f32_32x32x16_bf16 v[64:79], v[168:171], v[124:127], v[64:79]
    v_exp_f32 v87, v87
    v_cvt_pk_bf16_f32 v114, v84, v85
    v_exp_f32 v88, v88
    v_exp_f32 v89, v89
    v_cvt_pk_bf16_f32 v115, v86, v87
    v_exp_f32 v90, v90
    v_exp_f32 v91, v91
    v_cvt_pk_bf16_f32 v116, v88, v89
    v_exp_f32 v92, v92
    v_mfma_f32_32x32x16_bf16 v[48:63], v[156:159], v[112:115], v[48:63]
    v_exp_f32 v93, v93
    v_cvt_pk_bf16_f32 v117, v90, v91
    v_exp_f32 v94, v94
    v_exp_f32 v95, v95
    v_exp_f32 v96, v96
    v_cvt_pk_bf16_f32 v118, v92, v93
    s_waitcnt lgkmcnt(0)
    v_exp_f32 v97, v97
    v_cvt_pk_bf16_f32 v119, v94, v95
    v_exp_f32 v98, v98
    v_mfma_f32_32x32x16_bf16 v[80:95], v[128:131], v[4:7], v[16:31]
    s_add_u32 s41, s41, 1
    v_exp_f32 v99, v99
    s_cmp_eq_u32 s41, 1
    v_cvt_pk_bf16_f32 v120, v96, v97
    v_exp_f32 v100, v100
    s_cbranch_scc1 L_pa_att_sync2
L_pa_att_sync2_ret:
    v_exp_f32 v101, v101
    v_mov_b32 v184, s41
    v_cvt_pk_bf16_f32 v121, v98, v99
    v_exp_f32 v102, v102
    v_mfma_f32_32x32x16_bf16 v[48:63], v[172:175], v[116:119], v[48:63]
    v_add_u32 v176, 16640, v176
    v_exp_f32 v103, v103
    ds_write_b32 v189, v184 offset:80
    v_cvt_pk_bf16_f32 v122, v100, v101
    v_exp_f32 v104, v104
    v_add_u32 v177, 16640, v177
    v_exp_f32 v105, v105
    v_cvt_pk_bf16_f32 v123, v102, v103
    v_exp_f32 v106, v106
    v_add_u32 v178, 16640, v178
    v_exp_f32 v107, v107
    v_cvt_pk_bf16_f32 v124, v104, v105
    v_exp_f32 v108, v108
    v_mfma_f32_32x32x16_bf16 v[64:79], v[156:159], v[120:123], v[64:79]
    v_exp_f32 v109, v109
    v_cvt_pk_bf16_f32 v125, v106, v107
    v_exp_f32 v110, v110
    s_cmp_lt_u32 s41, 8
    v_exp_f32 v111, v111
    s_cbranch_scc1 L_pa_att_loop
    v_cvt_pk_bf16_f32 v126, v108, v109
    v_cvt_pk_bf16_f32 v127, v110, v111
    s_mul_i32 s33, s32, 90112
    s_lshl_b32 s34, s27, 10
    s_add_u32 s33, s33, s34
    s_add_u32 s33, s33, 14680064
    v_mfma_f32_32x32x16_bf16 v[64:79], v[172:175], v[124:127], v[64:79]
    s_waitcnt lgkmcnt(0)
    s_mov_b32 s36, 0
    s_mov_b32 s40, 0x7800000
L_pa_att_chk:
    v_mul_f32 v184, 0, v56
    v_fmac_f32 v184, 0, v48
    v_fmac_f32 v184, 0, v49
    v_fmac_f32 v184, 0, v50
    v_fmac_f32 v184, 0, v51
    v_fmac_f32 v184, 0, v52
    v_fmac_f32 v184, 0, v53
    v_fmac_f32 v184, 0, v54
    v_fmac_f32 v184, 0, v55
    v_max3_f32 v185, |v48|, |v49|, |v50|
    v_max3_f32 v185, v185, |v51|, |v52|
    v_max3_f32 v185, v185, |v53|, |v54|
    v_max_f32_e64 v185, v185, |v55|
    v_mov_b32 v186, v185
    s_nop 1
    v_permlane32_swap_b32 v185, v186
    v_max_f32 v185, v185, v186
    v_cmp_u_f32 vcc, v184, v184
    v_cmp_gt_f32 s[38:39], s40, v185
    s_nop 0
    s_or_b64 vcc, vcc, s[38:39]
    s_cbranch_vccnz L_pa_att_slow
L_pa_att_fin:
    v_rcp_f32 v182, v56
    s_cmp_lg_u32 s36, 0
    v_mul_f32 v48, v48, v182
    v_mul_f32 v49, v49, v182
    v_mul_f32 v50, v50, v182
    v_mul_f32 v51, v51, v182
    v_mul_f32 v52, v52, v182
    v_mul_f32 v53, v53, v182
    v_mul_f32 v54, v54, v182
    v_mul_f32 v55, v55, v182
    v_cvt_pk_bf16_f32 v112, v48, v49
    v_cvt_pk_bf16_f32 v113, v50, v51
    v_cvt_pk_bf16_f32 v114, v52, v53
    v_cvt_pk_bf16_f32 v115, v54, v55
    buffer_store_dwordx4 v[112:115], v179, s[12:15], s33 offen sc1
    s_cbranch_scc1 L_pa_att_done
    s_mov_b32 s36, 1
    s_add_u32 s33, s33, 90112
    v_mov_b32 v48, v64
    v_mov_b32 v49, v65
    v_mov_b32 v50, v66
    v_mov_b32 v51, v67
    v_mov_b32 v52, v68
    v_mov_b32 v53, v69
    v_mov_b32 v54, v70
    v_mov_b32 v55, v71
    v_mov_b32 v56, v72
    v_mov_b32 v4, v8
    v_mov_b32 v5, v9
    v_mov_b32 v6, v10
    v_mov_b32 v7, v11
    s_branch L_pa_att_chk
L_pa_att_done:
    s_lshl_b32 s33, s32, 11
    s_lshl_b32 s34, s27, 7
    s_add_u32 s33, s33, s34
    s_add_u32 s33, s33, 28573696
    v_mov_b32 v184, s11
    s_waitcnt vmcnt(0)
    buffer_store_dword v184, off, s[12:15], s33 sc1
    s_endpgm
L_pa_att_sync2:
L_pa_att_f2:
    ds_read_b128 v[184:187], v188 offset:48
    s_waitcnt lgkmcnt(0)
    v_min_u32 v184, v184, v185
    v_min3_u32 v184, v184, v186, v187
    v_cmp_gt_u32 vcc, 1, v184
    s_cbranch_vccz L_pa_att_f2_ok
    s_sleep 1
    s_branch L_pa_att_f2
L_pa_att_f2_ok:
    s_branch L_pa_att_sync2_ret
L_pa_att_sync3:
    s_branch L_pa_att_sync2_ret
L_pa_att_slow:
    v_mov_b32 v182, 0xff800000
    s_mov_b32 s41, 0
    s_mov_b32 s37, s30
L_pa_att_sl1:
    buffer_load_dwordx4 v[128:131], v179, s[12:15], s37 offen sc1
    s_waitcnt vmcnt(0)
    v_mfma_f32_32x32x16_bf16 v[80:95], v[128:131], v[4:7], 0
    s_nop 11
    v_max3_f32 v182, v182, v80, v81
    v_max3_f32 v182, v182, v82, v83
    v_max3_f32 v182, v182, v84, v85
    v_max3_f32 v182, v182, v86, v87
    v_max3_f32 v182, v182, v88, v89
    v_max3_f32 v182, v182, v90, v91
    v_max3_f32 v182, v182, v92, v93
    v_max3_f32 v182, v182, v94, v95
    s_add_u32 s37, s37, 2048
    s_add_u32 s41, s41, 1
    s_cmp_lt_u32 s41, 64
    s_cbranch_scc1 L_pa_att_sl1
    v_mov_b32 v184, v182
    s_nop 1
    v_permlane32_swap_b32 v184, v182
    v_max_f32 v182, v182, v184
    v_sub_f32 v16, 0, v182
    v_mov_b32 v48, 0
    v_sub_f32 v17, 0, v182
    v_mov_b32 v49, 0
    v_sub_f32 v18, 0, v182
    v_mov_b32 v50, 0
    v_sub_f32 v19, 0, v182
    v_mov_b32 v51, 0
    v_sub_f32 v20, 0, v182
    v_mov_b32 v52, 0
    v_sub_f32 v21, 0, v182
    v_mov_b32 v53, 0
    v_sub_f32 v22, 0, v182
    v_mov_b32 v54, 0
    v_sub_f32 v23, 0, v182
    v_mov_b32 v55, 0
    v_sub_f32 v24, 0, v182
    v_mov_b32 v56, 0
    v_sub_f32 v25, 0, v182
    v_mov_b32 v57, 0
    v_sub_f32 v26, 0, v182
    v_mov_b32 v58, 0
    v_sub_f32 v27, 0, v182
    v_mov_b32 v59, 0
    v_sub_f32 v28, 0, v182
    v_mov_b32 v60, 0
    v_sub_f32 v29, 0, v182
    v_mov_b32 v61, 0
    v_sub_f32 v30, 0, v182
    v_mov_b32 v62, 0
    v_sub_f32 v31, 0, v182
    v_mov_b32 v63, 0
    v_mov_b32 v144, v190
    v_mov_b32 v160, v190
    v_mov_b32 v145, v190
    v_mov_b32 v161, v190
    v_mov_b32 v146, v190
    v_mov_b32 v162, v190
    v_mov_b32 v147, v190
    v_mov_b32 v163, v190
    s_mov_b32 s41, 0
    s_mov_b32 s37, s30
L_pa_att_sl2:
    buffer_load_dwordx4 v[128:131], v179, s[12:15], s37 offen sc1
    s_mov_b64 exec, s[48:49]
    buffer_load_dwordx4 v[144:147], v180, s[12:15], s37 offen sc1
    buffer_load_dwordx4 v[160:163], v181, s[12:15], s37 offen sc1
    s_mov_b64 exec, -1
    s_waitcnt vmcnt(0)
    v_mfma_f32_32x32x16_bf16 v[80:95], v[128:131], v[4:7], v[16:31]
    s_nop 11
    v_exp_f32 v80, v80
    v_exp_f32 v81, v81
    v_exp_f32 v82, v82
    v_exp_f32 v83, v83
    v_exp_f32 v84, v84
    v_exp_f32 v85, v85
    v_exp_f32 v86, v86
    v_exp_f32 v87, v87
    v_exp_f32 v88, v88
    v_exp_f32 v89, v89
    v_exp_f32 v90, v90
    v_exp_f32 v91, v91
    v_exp_f32 v92, v92
    v_exp_f32 v93, v93
    v_exp_f32 v94, v94
    v_exp_f32 v95, v95
    v_cvt_pk_bf16_f32 v112, v80, v81
    v_cvt_pk_bf16_f32 v113, v82, v83
    v_cvt_pk_bf16_f32 v114, v84, v85
    v_cvt_pk_bf16_f32 v115, v86, v87
    v_cvt_pk_bf16_f32 v116, v88, v89
    v_cvt_pk_bf16_f32 v117, v90, v91
    v_cvt_pk_bf16_f32 v118, v92, v93
    v_cvt_pk_bf16_f32 v119, v94, v95
    v_mfma_f32_32x32x16_bf16 v[48:63], v[144:147], v[112:115], v[48:63]
    s_nop 0
    v_mfma_f32_32x32x16_bf16 v[48:63], v[160:163], v[116:119], v[48:63]
    s_add_u32 s37, s37, 2048
    s_add_u32 s41, s41, 1
    s_cmp_lt_u32 s41, 64
    s_cbranch_scc1 L_pa_att_sl2
    s_nop 15
    s_branch L_pa_att_fin
L_pa_end:
    s_endpgm
CODE_END:
    s_endpgm
.section .rodata,"a"
.p2align 6
.amdhsa_kernel parallel_sum__mha_block__mixer_gmlp__prompt_kernel
  .amdhsa_next_free_vgpr 256
  .amdhsa_next_free_sgpr 102
  .amdhsa_accum_offset 256
  .amdhsa_group_segment_fixed_size 0
  .amdhsa_kernarg_size 88
  .amdhsa_user_sgpr_count 2
  .amdhsa_user_sgpr_kernarg_segment_ptr 1
  .amdhsa_system_sgpr_workgroup_id_x 1
  .amdhsa_float_denorm_mode_32 3
.end_amdhsa_kernel
```
